```python
import torch

def _softmax(x, axis=-1):
    return torch.softmax(x, dim=axis)
def _gelu(x):
    return torch.nn.functional.gelu(x, approximate="tanh")
def _silu(x):
    return torch.nn.functional.silu(x)
def _sigmoid(x):
    return torch.sigmoid(x)
def _layernorm(x, axis=-1, eps=1e-5):
    m = x.mean(dim=axis, keepdim=True)
    v = x.var(dim=axis, keepdim=True, unbiased=False)
    return (x - m) / torch.sqrt(v + eps)
def _scatter_add(tgt, idx, src, axis=0):
    return tgt.clone().index_add_(axis, idx, src)
def _segment_sum(src, seg, n):
    out = torch.zeros((n,) + src.shape[1:], dtype=src.dtype)
    return out.index_add_(0, seg, src)
def _pad(x, pw):
    flat = tuple(v for pair in reversed(pw) for v in pair)
    return torch.nn.functional.pad(x, flat)

kernel_name = 'standalone__gqa_softmax__near_ridge'

def setup_inputs():

    _w = (lambda a: (lambda t: t.to(torch.bfloat16) if t.is_floating_point() else t)(torch.as_tensor(a)))
    B, Hq, Hkv, Sq, Sk, D = 8, 32, 4, 80, 1024, 128
    return {
        "q": _w((lambda *s: torch.randn(*s, dtype=torch.bfloat16) * 0.8)(B, Hq, Sq, D)),
        "k": _w((lambda *s: torch.randn(*s, dtype=torch.bfloat16) * 0.8)(B, Hkv, Sk, D)),
        "v": _w((lambda *s: torch.randn(*s, dtype=torch.bfloat16) * 0.05)(B, Hkv, Sk, D)),
    }

def reference(q, k, v):
    B, Hq, Sq, D = q.shape
    Hkv = k.shape[1]
    rep = Hq // Hkv
    k = (lambda x, n, axis: torch.repeat_interleave(x, n, dim=axis))(k, rep, axis=1)
    v = (lambda x, n, axis: torch.repeat_interleave(x, n, dim=axis))(v, rep, axis=1)
    scale = D ** -0.5
    scores = torch.einsum("bhqd,bhkd->bhqk", q, k) * scale
    p = _softmax(scores, axis=-1)
    return torch.einsum("bhqk,bhkd->bhqd", p, v)
```

```asm
; @launch grid=(256,1,1) block=(256,1,1) lds=163840
.amdgcn_target "amdgcn-amd-amdhsa--gfx950"
.text
.globl standalone__gqa_softmax__near_ridge_kernel
.p2align 8
.type standalone__gqa_softmax__near_ridge_kernel,@function
standalone__gqa_softmax__near_ridge_kernel:
    s_cmp_ge_u32 s2, 256
    s_cbranch_scc1 L_end
    s_load_dwordx8 s[4:11], s[0:1], 0
    s_getpc_b64 s[66:67]
L_pfbase:
    s_lshr_b32 s31, s2, 3
    s_lshl_b32 s31, s31, 9
    v_and_b32 v224, 0x30, v0
    v_lshl_add_u32 v224, v224, 3, s31
    v_min_u32 v224, L_end - L_pfbase, v224
    v_mov_b32 v225, s67
    v_add_co_u32 v224, vcc, s66, v224
    s_nop 1
    v_addc_co_u32 v225, vcc, 0, v225, vcc
    global_load_dword v228, v[224:225], off
    v_lshrrev_b32 v144, 6, v0
    v_lshlrev_b32 v148, 4, v0
    v_readfirstlane_b32 s28, v144
    s_and_b32 s33, s2, 7
    s_lshr_b32 s36, s2, 3
    s_and_b32 s37, s36, 3
    s_lshl_b32 s33, s33, 2
    s_add_u32 s33, s33, s37
    s_lshr_b32 s36, s36, 2
    s_lshl_b32 s37, s33, 3
    s_add_u32 s37, s37, s36
    s_mul_i32 s38, s37, 20480
    s_mov_b32 s56, 0
    s_mov_b32 s57, 4096
    s_mov_b32 s58, 8192
    s_mov_b32 s59, 12288
    s_mov_b32 s60, 16384
    s_mov_b32 s14, 20480
    s_mov_b32 s15, 0x20000
    s_lshl_b32 s39, s33, 18
    v_and_b32 v1, 63, v0
    v_lshrrev_b32 v145, 4, v1
    v_and_b32 v146, 15, v1
    v_xor_b32 v147, v146, v145
    v_lshlrev_b32 v147, 4, v147
    v_lshl_add_u32 v196, v145, 8, v147
    v_xor_b32 v197, 64, v196
    v_xor_b32 v198, 128, v196
    v_xor_b32 v199, 192, v196
    s_mul_i32 s30, s28, 40960
    s_lshl_b32 s64, s28, 13
    s_add_u32 s39, s39, s64
    s_sub_u32 s18, 0x40000, s64
    s_mov_b32 s19, 0x20000
    s_lshl_b32 s29, s28, 1
    s_sub_u32 s29, s36, s29
    s_and_b32 s29, s29, 7
    s_mov_b32 s40, 0
    s_cmp_eq_u32 s29, 0
    s_cselect_b32 s40, 32768, s40
    s_add_u32 s41, s40, 4096
    s_add_u32 m0, s30, 0
    s_waitcnt lgkmcnt(0)
    s_add_u32 s12, s4, s38
    s_addc_u32 s13, s5, 0
    buffer_load_dwordx4 v[84:87], v148, s[12:15], s56 offen
    s_add_u32 s16, s6, s39
    s_addc_u32 s17, s7, 0
    buffer_load_dwordx4 v[88:91], v148, s[12:15], s57 offen
    buffer_load_dwordx4 v[92:95], v148, s[12:15], s58 offen
    buffer_load_dwordx4 v[96:99], v148, s[12:15], s59 offen
    buffer_load_dwordx4 v[100:103], v148, s[12:15], s60 offen
    buffer_load_dwordx4 v196, s[16:19], s40 offen offset:0 lds
    buffer_load_dwordx4 v197, s[16:19], s40 offen offset:1024 lds
    buffer_load_dwordx4 v198, s[16:19], s40 offen offset:2048 lds
    buffer_load_dwordx4 v199, s[16:19], s40 offen offset:3072 lds
    s_add_u32 s20, s8, s39
    s_addc_u32 s21, s9, 0
    s_mov_b32 s22, s18
    s_mov_b32 s23, 0x20000
    v_and_b32 v226, 7, v1
    v_lshlrev_b32 v226, 7, v226
    s_lshl_b32 s31, s36, 10
    s_mov_b32 s42, 32768
    s_cmp_eq_u32 s29, 1
    s_cselect_b32 s42, 65536, s42
    s_cmp_eq_u32 s29, 0
    s_cselect_b32 s42, 0, s42
    s_add_u32 s43, s42, 4096
    s_mov_b32 s44, 65536
    s_cmp_eq_u32 s29, 2
    s_cselect_b32 s44, 98304, s44
    s_cmp_eq_u32 s29, 1
    s_cselect_b32 s44, 32768, s44
    s_add_u32 s45, s44, 4096
    s_mov_b32 s46, 98304
    s_cmp_eq_u32 s29, 3
    s_cselect_b32 s46, 131072, s46
    s_cmp_eq_u32 s29, 2
    s_cselect_b32 s46, 65536, s46
    s_add_u32 s47, s46, 4096
    s_mov_b32 s48, 131072
    s_cmp_eq_u32 s29, 4
    s_cselect_b32 s48, 163840, s48
    s_cmp_eq_u32 s29, 3
    s_cselect_b32 s48, 98304, s48
    s_add_u32 s49, s48, 4096
    s_mov_b32 s50, 163840
    s_cmp_eq_u32 s29, 5
    s_cselect_b32 s50, 196608, s50
    s_cmp_eq_u32 s29, 4
    s_cselect_b32 s50, 131072, s50
    s_add_u32 s51, s50, 4096
    s_mov_b32 s52, 196608
    s_add_u32 m0, s30, 4096
    s_nop 0
    buffer_load_dwordx4 v196, s[16:19], s41 offen offset:0 lds
    s_cmp_eq_u32 s29, 6
    s_cselect_b32 s52, 229376, s52
    s_cmp_eq_u32 s29, 5
    s_cselect_b32 s52, 163840, s52
    s_add_u32 s53, s52, 4096
    s_mov_b32 s54, 229376
    s_cmp_eq_u32 s29, 6
    s_cselect_b32 s54, 196608, s54
    s_add_u32 s55, s54, 4096
    s_add_u32 s24, s10, s38
    s_addc_u32 s25, s11, 0
    s_mov_b32 s26, 20480
    s_mov_b32 s27, 0x20000
    s_mov_b32 s34, 0x3e0293ee
    s_mov_b32 s35, 0x3e0293ee
    s_mov_b32 s32, 0
    s_lshl_b32 s62, s28, 6
    s_lshl_b32 s63, s28, 10
    v_xor_b32 v154, s62, v196
    v_add_u32 v154, s63, v154
    v_add_u32 v154, 32768, v154
    v_add_u32 v155, 81920, v154
    v_lshl_add_u32 v52, v146, 8, v147
    v_xor_b32 v53, 64, v52
    v_xor_b32 v54, 128, v52
    v_xor_b32 v55, 192, v52
    v_add_u32 v184, s30, v52
    v_add_u32 v44, 32768, v52
    v_add_u32 v48, 114688, v52
    v_add_u32 v185, s30, v53
    v_add_u32 v45, 32768, v53
    buffer_load_dwordx4 v197, s[16:19], s41 offen offset:1024 lds
    v_add_u32 v49, 114688, v53
    v_add_u32 v186, s30, v54
    v_add_u32 v46, 32768, v54
    v_add_u32 v50, 114688, v54
    v_add_u32 v187, s30, v55
    v_add_u32 v47, 32768, v55
    v_add_u32 v51, 114688, v55
    v_lshlrev_b32 v2, 4, v1
    v_add_u32 v2, s30, v2
    v_lshlrev_b32 v3, 5, v146
    v_lshlrev_b32 v219, 2, v146
    v_add_u32 v219, 8192, v219
    v_add_u32 v220, 81920, v219
    v_add_u32 v222, s30, v219
    v_add_u32 v3, 155648, v3
    v_mov_b32 v204, 0xff800000
    v_mov_b32 v205, 0xff800000
    v_mov_b32 v206, 0xff800000
    v_mov_b32 v207, 0xff800000
    v_mov_b32 v208, 0xff800000
    v_lshlrev_b32 v153, 2, v145
    v_xor_b32 v153, v153, v146
    v_lshlrev_b32 v153, 4, v153
    v_lshl_add_u32 v200, v145, 8, v153
    v_xor_b32 v201, 32, v200
    v_lshrrev_b32 v150, 2, v146
    v_and_b32 v151, 3, v146
    v_and_b32 v152, 1, v145
    buffer_load_dwordx4 v198, s[16:19], s41 offen offset:2048 lds
    v_lshlrev_b32 v153, 3, v151
    v_lshl_add_u32 v153, v150, 8, v153
    v_lshl_add_u32 v153, v150, 6, v153
    v_lshl_add_u32 v153, v152, 5, v153
    v_lshl_add_u32 v153, v145, 10, v153
    v_add_u32 v153, s30, v153
    s_add_u32 s65, s28, 1
    s_and_b32 s65, s65, 3
    s_lshl_b32 s65, s65, 6
    v_xor_b32 v188, s65, v153
    v_xor_b32 v189, 32, v188
    s_add_u32 s65, s28, 2
    s_and_b32 s65, s65, 3
    s_lshl_b32 s65, s65, 6
    v_xor_b32 v190, s65, v153
    v_xor_b32 v191, 32, v190
    s_add_u32 s65, s28, 3
    s_and_b32 s65, s65, 3
    s_lshl_b32 s65, s65, 6
    v_xor_b32 v192, s65, v153
    v_xor_b32 v193, 32, v192
    s_add_u32 s65, s28, 4
    s_and_b32 s65, s65, 3
    s_lshl_b32 s65, s65, 6
    v_xor_b32 v194, s65, v153
    v_xor_b32 v195, 32, v194
    v_mov_b32 v149, 0x3f803f80
    v_accvgpr_write_b32 a252, v149
    buffer_load_dwordx4 v199, s[16:19], s41 offen offset:3072 lds
    v_accvgpr_write_b32 a253, v149
    v_accvgpr_write_b32 a254, v149
    v_accvgpr_write_b32 a255, v149
    s_add_u32 s64, s28, 3
    s_and_b32 s64, s64, 3
    s_mul_i32 s64, s64, 40960
    s_sub_u32 s64, s64, s30
    v_add_u32 v216, s64, v2
    s_add_u32 s64, s28, 2
    s_and_b32 s64, s64, 3
    s_mul_i32 s64, s64, 40960
    s_sub_u32 s64, s64, s30
    v_add_u32 v217, s64, v2
    s_add_u32 s64, s28, 1
    s_and_b32 s64, s64, 3
    s_mul_i32 s64, s64, 40960
    s_sub_u32 s64, s64, s30
    v_add_u32 v218, s64, v2
    v_lshrrev_b32 v156, 2, v1
    v_lshlrev_b32 v157, 4, v151
    v_lshl_add_u32 v223, v156, 8, v157
    v_mul_u32_u24 v214, 80, v156
    v_add3_u32 v214, v214, v157, s30
    v_mul_u32_u24 v215, 80, v146
    v_lshl_add_u32 v215, v145, 3, v215
    v_add_u32 v215, s30, v215
    v_add_u32 v223, s62, v223
    s_mov_b32 s67, 0x49800000
    s_mov_b64 s[36:37], 0
    s_waitcnt vmcnt(12)
    v_lshlrev_b32 v124, 16, v84
    v_and_b32 v125, 0xffff0000, v84
    v_pk_mul_f32 v[124:125], v[124:125], s[34:35]
    v_cvt_pk_bf16_f32 v84, v124, v125
    v_lshlrev_b32 v126, 16, v85
    v_and_b32 v127, 0xffff0000, v85
    v_pk_mul_f32 v[126:127], v[126:127], s[34:35]
    v_cvt_pk_bf16_f32 v85, v126, v127
    v_lshlrev_b32 v128, 16, v86
    v_and_b32 v129, 0xffff0000, v86
    v_pk_mul_f32 v[128:129], v[128:129], s[34:35]
    v_cvt_pk_bf16_f32 v86, v128, v129
    v_lshlrev_b32 v130, 16, v87
    v_and_b32 v131, 0xffff0000, v87
    v_pk_mul_f32 v[130:131], v[130:131], s[34:35]
    v_cvt_pk_bf16_f32 v87, v130, v131
    s_add_u32 m0, s30, 8192
    ds_write_b128 v154, v[84:87] offset:0
    buffer_load_dwordx4 v196, s[16:19], s42 offen offset:0 lds
    s_waitcnt vmcnt(12)
    v_lshlrev_b32 v124, 16, v88
    v_and_b32 v125, 0xffff0000, v88
    v_pk_mul_f32 v[124:125], v[124:125], s[34:35]
    v_cvt_pk_bf16_f32 v88, v124, v125
    v_lshlrev_b32 v126, 16, v89
    v_and_b32 v127, 0xffff0000, v89
    v_pk_mul_f32 v[126:127], v[126:127], s[34:35]
    v_cvt_pk_bf16_f32 v89, v126, v127
    v_lshlrev_b32 v128, 16, v90
    v_and_b32 v129, 0xffff0000, v90
    v_pk_mul_f32 v[128:129], v[128:129], s[34:35]
    v_cvt_pk_bf16_f32 v90, v128, v129
    v_lshlrev_b32 v130, 16, v91
    v_and_b32 v131, 0xffff0000, v91
    v_pk_mul_f32 v[130:131], v[130:131], s[34:35]
    v_cvt_pk_bf16_f32 v91, v130, v131
    ds_write_b128 v154, v[88:91] offset:4096
    s_xor_b32 s33, s31, 0
    s_mov_b64 exec, 0xff
    buffer_load_dword v227, v226, s[20:23], s33 offen
    s_mov_b64 exec, -1
    buffer_load_dwordx4 v197, s[16:19], s42 offen offset:1024 lds
    s_waitcnt vmcnt(13)
    v_lshlrev_b32 v124, 16, v92
    v_and_b32 v125, 0xffff0000, v92
    v_pk_mul_f32 v[124:125], v[124:125], s[34:35]
    v_cvt_pk_bf16_f32 v92, v124, v125
    v_lshlrev_b32 v126, 16, v93
    v_and_b32 v127, 0xffff0000, v93
    v_pk_mul_f32 v[126:127], v[126:127], s[34:35]
    v_cvt_pk_bf16_f32 v93, v126, v127
    v_lshlrev_b32 v128, 16, v94
    v_and_b32 v129, 0xffff0000, v94
    v_pk_mul_f32 v[128:129], v[128:129], s[34:35]
    v_cvt_pk_bf16_f32 v94, v128, v129
    v_lshlrev_b32 v130, 16, v95
    v_and_b32 v131, 0xffff0000, v95
    v_pk_mul_f32 v[130:131], v[130:131], s[34:35]
    v_cvt_pk_bf16_f32 v95, v130, v131
    ds_write_b128 v154, v[92:95] offset:40960
    buffer_load_dwordx4 v198, s[16:19], s42 offen offset:2048 lds
    s_waitcnt vmcnt(13)
    v_lshlrev_b32 v124, 16, v96
    v_and_b32 v125, 0xffff0000, v96
    v_pk_mul_f32 v[124:125], v[124:125], s[34:35]
    v_cvt_pk_bf16_f32 v96, v124, v125
    v_lshlrev_b32 v126, 16, v97
    v_and_b32 v127, 0xffff0000, v97
    v_pk_mul_f32 v[126:127], v[126:127], s[34:35]
    v_cvt_pk_bf16_f32 v97, v126, v127
    v_lshlrev_b32 v128, 16, v98
    v_and_b32 v129, 0xffff0000, v98
    v_pk_mul_f32 v[128:129], v[128:129], s[34:35]
    v_cvt_pk_bf16_f32 v98, v128, v129
    v_lshlrev_b32 v130, 16, v99
    v_and_b32 v131, 0xffff0000, v99
    v_pk_mul_f32 v[130:131], v[130:131], s[34:35]
    v_cvt_pk_bf16_f32 v99, v130, v131
    ds_write_b128 v154, v[96:99] offset:45056
    buffer_load_dwordx4 v199, s[16:19], s42 offen offset:3072 lds
    s_waitcnt vmcnt(13)
    v_lshlrev_b32 v124, 16, v100
    v_and_b32 v125, 0xffff0000, v100
    v_pk_mul_f32 v[124:125], v[124:125], s[34:35]
    v_cvt_pk_bf16_f32 v100, v124, v125
    v_lshlrev_b32 v126, 16, v101
    v_and_b32 v127, 0xffff0000, v101
    v_pk_mul_f32 v[126:127], v[126:127], s[34:35]
    v_cvt_pk_bf16_f32 v101, v126, v127
    v_lshlrev_b32 v128, 16, v102
    v_and_b32 v129, 0xffff0000, v102
    v_pk_mul_f32 v[128:129], v[128:129], s[34:35]
    v_cvt_pk_bf16_f32 v102, v128, v129
    v_lshlrev_b32 v130, 16, v103
    v_and_b32 v131, 0xffff0000, v103
    v_pk_mul_f32 v[130:131], v[130:131], s[34:35]
    v_cvt_pk_bf16_f32 v103, v130, v131
    s_add_u32 m0, s30, 12288
    ds_write_b128 v155, v[100:103] offset:0
    buffer_load_dwordx4 v196, s[16:19], s43 offen offset:0 lds
    s_xor_b32 s33, s31, 32768
    s_mov_b64 exec, 0xff
    buffer_load_dword v227, v226, s[20:23], s33 offen
    s_mov_b64 exec, -1
    s_waitcnt lgkmcnt(0)
    s_waitcnt vmcnt(11)
    s_barrier
L_main:
    ds_read_b128 a[120:123], v44 offset:0
    ds_read_b128 a[216:219], v52 offset:0
    ds_read_b128 a[124:127], v45 offset:0
    ds_read_b128 a[220:223], v53 offset:0
    ds_read_b128 a[128:131], v46 offset:0
    ds_read_b128 a[224:227], v54 offset:0
    ds_read_b128 a[132:135], v47 offset:0
    ds_read_b128 a[228:231], v55 offset:0
    ds_read_b128 a[136:139], v44 offset:4096
    ds_read_b128 a[140:143], v45 offset:4096
    ds_read_b128 a[144:147], v46 offset:4096
    ds_read_b128 a[148:151], v47 offset:4096
    ds_read_b128 a[152:155], v44 offset:40960
    ds_read_b128 a[156:159], v45 offset:40960
    ds_read_b128 a[160:163], v46 offset:40960
    s_waitcnt lgkmcnt(13)
    v_mfma_f32_16x16x32_bf16 v[84:87], a[216:219], a[120:123], 0
    buffer_load_dwordx4 v197, s[16:19], s43 offen offset:1024 lds
    ds_read_b128 a[164:167], v47 offset:40960
    s_waitcnt lgkmcnt(12)
    v_mfma_f32_16x16x32_bf16 v[84:87], a[220:223], a[124:127], v[84:87]
    ds_read_b128 a[168:171], v44 offset:45056
    s_waitcnt lgkmcnt(11)
    v_mfma_f32_16x16x32_bf16 v[84:87], a[224:227], a[128:131], v[84:87]
    ds_read_b128 a[172:175], v45 offset:45056
    s_waitcnt lgkmcnt(10)
    v_mfma_f32_16x16x32_bf16 v[84:87], a[228:231], a[132:135], v[84:87]
    ds_read_b128 a[176:179], v46 offset:45056
    s_waitcnt lgkmcnt(10)
    v_mfma_f32_16x16x32_bf16 v[88:91], a[216:219], a[136:139], 0
    buffer_load_dwordx4 v198, s[16:19], s43 offen offset:2048 lds
    ds_read_b128 a[180:183], v47 offset:45056
    s_waitcnt lgkmcnt(10)
    v_mfma_f32_16x16x32_bf16 v[88:91], a[220:223], a[140:143], v[88:91]
    ds_read_b128 a[184:187], v48 offset:0
    s_waitcnt lgkmcnt(10)
    v_mfma_f32_16x16x32_bf16 v[88:91], a[224:227], a[144:147], v[88:91]
    ds_read_b128 a[188:191], v49 offset:0
    v_max3_f32 v204, v84, v85, v204
    s_waitcnt lgkmcnt(10)
    v_mfma_f32_16x16x32_bf16 v[88:91], a[228:231], a[148:151], v[88:91]
    ds_read_b128 a[192:195], v50 offset:0
    v_max3_f32 v204, v86, v87, v204
    s_waitcnt lgkmcnt(10)
    v_mfma_f32_16x16x32_bf16 v[92:95], a[216:219], a[152:155], 0
    buffer_load_dwordx4 v199, s[16:19], s43 offen offset:3072 lds
    ds_read_b128 a[196:199], v51 offset:0
L_main3:
    s_waitcnt lgkmcnt(10)
    v_mfma_f32_16x16x32_bf16 v[92:95], a[220:223], a[156:159], v[92:95]
    s_add_u32 m0, s30, 16384
    v_mov_b32 v104, v204
    v_max3_f32 v205, v88, v89, v205
    s_waitcnt lgkmcnt(5)
    v_mfma_f32_16x16x32_bf16 v[92:95], a[224:227], a[160:163], v[92:95]
    ds_read_b128 a[200:203], v184 offset:0
    ds_read_b128 a[204:207], v185 offset:0
    v_mfma_f32_16x16x32_bf16 v[92:95], a[228:231], a[164:167], v[92:95]
    ds_read_b128 a[208:211], v186 offset:0
    ds_read_b128 a[212:215], v187 offset:0
    v_mfma_f32_16x16x32_bf16 v[96:99], a[216:219], a[168:171], 0
    buffer_load_dwordx4 v196, s[16:19], s44 offen offset:0 lds
    v_permlane16_swap_b32 v204, v104
    v_mfma_f32_16x16x32_bf16 v[96:99], a[220:223], a[172:175], v[96:99]
    v_max_f32 v204, v204, v104
    v_mov_b32 v104, v204
    v_mfma_f32_16x16x32_bf16 v[96:99], a[224:227], a[176:179], v[96:99]
    s_waitcnt lgkmcnt(5)
    v_max3_f32 v205, v90, v91, v205
    v_permlane32_swap_b32 v204, v104
    v_mfma_f32_16x16x32_bf16 v[96:99], a[228:231], a[180:183], v[96:99]
    v_max_f32 v204, v204, v104
    v_sub_f32 v124, 0, v204
    v_mfma_f32_16x16x32_bf16 v[100:103], a[216:219], a[184:187], 0
    buffer_load_dwordx4 v197, s[16:19], s44 offen offset:1024 lds
    v_sub_f32 v125, 0, v204
    v_mfma_f32_16x16x32_bf16 v[100:103], a[220:223], a[188:191], v[100:103]
    v_sub_f32 v126, 0, v204
    v_sub_f32 v127, 0, v204
    v_mfma_f32_16x16x32_bf16 v[100:103], a[224:227], a[192:195], v[100:103]
    s_waitcnt lgkmcnt(0)
    v_mov_b32 v105, v205
    v_max3_f32 v206, v92, v93, v206
    v_mfma_f32_16x16x32_bf16 v[100:103], a[228:231], a[196:199], v[100:103]
    v_permlane16_swap_b32 v205, v105
    v_max_f32 v205, v205, v105
    v_mfma_f32_16x16x32_bf16 v[4:7], a[200:203], a[120:123], v[124:127]
    buffer_load_dwordx4 v198, s[16:19], s44 offen offset:2048 lds
    v_mov_b32 v105, v205
    v_mfma_f32_16x16x32_bf16 v[4:7], a[204:207], a[124:127], v[4:7]
    v_max3_f32 v206, v94, v95, v206
    v_permlane32_swap_b32 v205, v105
    v_mfma_f32_16x16x32_bf16 v[4:7], a[208:211], a[128:131], v[4:7]
    v_max_f32 v205, v205, v105
    v_sub_f32 v128, 0, v205
    v_mfma_f32_16x16x32_bf16 v[4:7], a[212:215], a[132:135], v[4:7]
    v_sub_f32 v129, 0, v205
    v_sub_f32 v130, 0, v205
    v_sub_f32 v131, 0, v205
    v_mov_b32 v106, v206
    v_max3_f32 v207, v96, v97, v207
    v_mfma_f32_16x16x32_bf16 v[12:15], a[200:203], a[136:139], v[128:131]
    buffer_load_dwordx4 v199, s[16:19], s44 offen offset:3072 lds
    v_permlane16_swap_b32 v206, v106
    v_mfma_f32_16x16x32_bf16 v[12:15], a[204:207], a[140:143], v[12:15]
    s_add_u32 m0, s30, 20480
    v_max_f32 v206, v206, v106
    v_mov_b32 v106, v206
    v_mfma_f32_16x16x32_bf16 v[12:15], a[208:211], a[144:147], v[12:15]
    s_waitcnt vmcnt(14)
    ds_read_b128 a[216:219], v184 offset:4096
    v_permlane32_swap_b32 v206, v106
    v_mfma_f32_16x16x32_bf16 v[12:15], a[212:215], a[148:151], v[12:15]
    v_max_f32 v206, v206, v106
    v_sub_f32 v132, 0, v206
    v_sub_f32 v133, 0, v206
    v_sub_f32 v134, 0, v206
    v_sub_f32 v135, 0, v206
    v_max3_f32 v207, v98, v99, v207
    v_mov_b32 v107, v207
    v_mfma_f32_16x16x32_bf16 v[20:23], a[200:203], a[152:155], v[132:135]
    buffer_load_dwordx4 v196, s[16:19], s45 offen offset:0 lds
    v_permlane16_swap_b32 v207, v107
    v_mfma_f32_16x16x32_bf16 v[20:23], a[204:207], a[156:159], v[20:23]
    s_barrier
    v_max_f32 v207, v207, v107
    v_mov_b32 v107, v207
    v_mfma_f32_16x16x32_bf16 v[20:23], a[208:211], a[160:163], v[20:23]
    ds_read_b128 a[220:223], v185 offset:4096
    v_permlane32_swap_b32 v207, v107
    v_mfma_f32_16x16x32_bf16 v[20:23], a[212:215], a[164:167], v[20:23]
    v_max_f32 v207, v207, v107
    v_sub_f32 v136, 0, v207
    v_sub_f32 v137, 0, v207
    v_sub_f32 v138, 0, v207
    v_sub_f32 v139, 0, v207
    v_max3_f32 v208, v100, v101, v208
    v_max3_f32 v208, v102, v103, v208
    v_mfma_f32_16x16x32_bf16 v[28:31], a[200:203], a[168:171], v[136:139]
    buffer_load_dwordx4 v197, s[16:19], s45 offen offset:1024 lds
    v_mov_b32 v108, v208
    v_mfma_f32_16x16x32_bf16 v[28:31], a[204:207], a[172:175], v[28:31]
    ds_read_b128 a[224:227], v186 offset:4096
    v_permlane16_swap_b32 v208, v108
    v_mfma_f32_16x16x32_bf16 v[28:31], a[208:211], a[176:179], v[28:31]
    ds_read_b128 a[228:231], v187 offset:4096
    v_max_f32 v208, v208, v108
    v_mfma_f32_16x16x32_bf16 v[28:31], a[212:215], a[180:183], v[28:31]
    v_mov_b32 v108, v208
    v_exp_f32 v4, v4
    v_exp_f32 v5, v5
    v_permlane32_swap_b32 v208, v108
    v_max_f32 v208, v208, v108
    v_sub_f32 v140, 0, v208
    v_sub_f32 v141, 0, v208
    v_sub_f32 v142, 0, v208
    v_sub_f32 v143, 0, v208
    buffer_load_dwordx4 v198, s[16:19], s45 offen offset:2048 lds
    v_exp_f32 v6, v6
    v_mfma_f32_16x16x32_bf16 v[36:39], a[200:203], a[184:187], v[140:143]
    v_exp_f32 v7, v7
    v_mfma_f32_16x16x32_bf16 v[36:39], a[204:207], a[188:191], v[36:39]
    v_cvt_pk_bf16_f32 v4, v4, v5
    v_cvt_pk_bf16_f32 v5, v6, v7
    v_mfma_f32_16x16x32_bf16 v[36:39], a[208:211], a[192:195], v[36:39]
    s_waitcnt lgkmcnt(0)
    v_exp_f32 v12, v12
    v_mfma_f32_16x16x32_bf16 v[36:39], a[212:215], a[196:199], v[36:39]
    buffer_load_dwordx4 v199, s[16:19], s45 offen offset:3072 lds
    v_mfma_f32_16x16x32_bf16 v[8:11], a[216:219], a[120:123], v[124:127]
    s_add_u32 m0, s30, 24576
    v_exp_f32 v13, v13
    v_mfma_f32_16x16x32_bf16 v[8:11], a[220:223], a[124:127], v[8:11]
    v_exp_f32 v14, v14
    v_mfma_f32_16x16x32_bf16 v[8:11], a[224:227], a[128:131], v[8:11]
    s_waitcnt vmcnt(13)
    v_exp_f32 v15, v15
    v_mfma_f32_16x16x32_bf16 v[8:11], a[228:231], a[132:135], v[8:11]
    buffer_load_dwordx4 v200, s[20:23], s40 offen offset:0 lds
    v_cvt_pk_bf16_f32 v12, v12, v13
    v_mfma_f32_16x16x32_bf16 v[16:19], a[216:219], a[136:139], v[128:131]
    ds_read_b128 a[200:203], v184 offset:8192
    ds_read_b128 a[204:207], v185 offset:8192
    v_mfma_f32_16x16x32_bf16 v[16:19], a[220:223], a[140:143], v[16:19]
    ds_read_b128 a[208:211], v186 offset:8192
    ds_read_b128 a[212:215], v187 offset:8192
    v_mfma_f32_16x16x32_bf16 v[16:19], a[224:227], a[144:147], v[16:19]
    v_exp_f32 v8, v8
    v_mfma_f32_16x16x32_bf16 v[16:19], a[228:231], a[148:151], v[16:19]
    buffer_load_dwordx4 v201, s[20:23], s40 offen offset:1024 lds
    v_cvt_pk_bf16_f32 v13, v14, v15
    v_mfma_f32_16x16x32_bf16 v[24:27], a[216:219], a[152:155], v[132:135]
    v_exp_f32 v9, v9
    v_mfma_f32_16x16x32_bf16 v[24:27], a[220:223], a[156:159], v[24:27]
    v_exp_f32 v10, v10
    v_mfma_f32_16x16x32_bf16 v[24:27], a[224:227], a[160:163], v[24:27]
    v_exp_f32 v11, v11
    v_mfma_f32_16x16x32_bf16 v[24:27], a[228:231], a[164:167], v[24:27]
    buffer_load_dwordx4 v200, s[20:23], s40 offen offset:2048 lds
    v_cvt_pk_bf16_f32 v6, v8, v9
    v_mfma_f32_16x16x32_bf16 v[32:35], a[216:219], a[168:171], v[136:139]
    v_cvt_pk_bf16_f32 v7, v10, v11
    v_mfma_f32_16x16x32_bf16 v[32:35], a[220:223], a[172:175], v[32:35]
    v_exp_f32 v16, v16
    v_mfma_f32_16x16x32_bf16 v[32:35], a[224:227], a[176:179], v[32:35]
    v_exp_f32 v17, v17
    v_mfma_f32_16x16x32_bf16 v[32:35], a[228:231], a[180:183], v[32:35]
    buffer_load_dwordx4 v201, s[20:23], s40 offen offset:3072 lds
    v_cvt_pk_bf16_f32 v14, v16, v17
    v_mfma_f32_16x16x32_bf16 v[40:43], a[216:219], a[184:187], v[140:143]
    s_add_u32 m0, s30, 28672
    v_exp_f32 v18, v18
    v_mfma_f32_16x16x32_bf16 v[40:43], a[220:223], a[188:191], v[40:43]
    v_exp_f32 v19, v19
    v_mfma_f32_16x16x32_bf16 v[40:43], a[224:227], a[192:195], v[40:43]
    s_waitcnt lgkmcnt(0)
    v_exp_f32 v20, v20
    v_mfma_f32_16x16x32_bf16 v[40:43], a[228:231], a[196:199], v[40:43]
    buffer_load_dwordx4 v200, s[20:23], s41 offen offset:0 lds
    v_cvt_pk_bf16_f32 v15, v18, v19
    v_mfma_f32_16x16x32_bf16 v[44:47], a[200:203], a[120:123], v[124:127]
    v_exp_f32 v21, v21
    v_mfma_f32_16x16x32_bf16 v[44:47], a[204:207], a[124:127], v[44:47]
    v_exp_f32 v22, v22
    v_mfma_f32_16x16x32_bf16 v[44:47], a[208:211], a[128:131], v[44:47]
    s_waitcnt vmcnt(13)
    v_exp_f32 v23, v23
    v_mfma_f32_16x16x32_bf16 v[44:47], a[212:215], a[132:135], v[44:47]
    buffer_load_dwordx4 v201, s[20:23], s41 offen offset:1024 lds
    v_cvt_pk_bf16_f32 v20, v20, v21
    v_mfma_f32_16x16x32_bf16 v[52:55], a[200:203], a[136:139], v[128:131]
    ds_read_b128 a[216:219], v184 offset:12288
    ds_read_b128 a[220:223], v185 offset:12288
    v_mfma_f32_16x16x32_bf16 v[52:55], a[204:207], a[140:143], v[52:55]
    ds_read_b128 a[224:227], v186 offset:12288
    ds_read_b128 a[228:231], v187 offset:12288
    v_mfma_f32_16x16x32_bf16 v[52:55], a[208:211], a[144:147], v[52:55]
    v_exp_f32 v24, v24
    v_mfma_f32_16x16x32_bf16 v[52:55], a[212:215], a[148:151], v[52:55]
    buffer_load_dwordx4 v200, s[20:23], s41 offen offset:2048 lds
    v_cvt_pk_bf16_f32 v21, v22, v23
    v_mfma_f32_16x16x32_bf16 v[60:63], a[200:203], a[152:155], v[132:135]
    v_exp_f32 v25, v25
    v_mfma_f32_16x16x32_bf16 v[60:63], a[204:207], a[156:159], v[60:63]
    v_exp_f32 v26, v26
    v_mfma_f32_16x16x32_bf16 v[60:63], a[208:211], a[160:163], v[60:63]
    v_exp_f32 v27, v27
    v_mfma_f32_16x16x32_bf16 v[60:63], a[212:215], a[164:167], v[60:63]
    buffer_load_dwordx4 v201, s[20:23], s41 offen offset:3072 lds
    v_cvt_pk_bf16_f32 v22, v24, v25
    v_mfma_f32_16x16x32_bf16 v[68:71], a[200:203], a[168:171], v[136:139]
    s_add_u32 m0, s30, 32768
    v_exp_f32 v28, v28
    v_mfma_f32_16x16x32_bf16 v[68:71], a[204:207], a[172:175], v[68:71]
    v_exp_f32 v29, v29
    v_mfma_f32_16x16x32_bf16 v[68:71], a[208:211], a[176:179], v[68:71]
    v_exp_f32 v30, v30
    v_mfma_f32_16x16x32_bf16 v[68:71], a[212:215], a[180:183], v[68:71]
    buffer_load_dwordx4 v196, s[16:19], s46 offen offset:0 lds
    v_cvt_pk_bf16_f32 v23, v26, v27
    v_mfma_f32_16x16x32_bf16 v[76:79], a[200:203], a[184:187], v[140:143]
    v_exp_f32 v31, v31
    v_mfma_f32_16x16x32_bf16 v[76:79], a[204:207], a[188:191], v[76:79]
    v_exp_f32 v32, v32
    v_mfma_f32_16x16x32_bf16 v[76:79], a[208:211], a[192:195], v[76:79]
    s_waitcnt lgkmcnt(0)
    v_exp_f32 v33, v33
    v_mfma_f32_16x16x32_bf16 v[76:79], a[212:215], a[196:199], v[76:79]
    buffer_load_dwordx4 v197, s[16:19], s46 offen offset:1024 lds
    v_cvt_pk_bf16_f32 v28, v28, v29
    v_mfma_f32_16x16x32_bf16 v[48:51], a[216:219], a[120:123], v[124:127]
    v_exp_f32 v34, v34
    v_mfma_f32_16x16x32_bf16 v[48:51], a[220:223], a[124:127], v[48:51]
    v_exp_f32 v35, v35
    v_mfma_f32_16x16x32_bf16 v[48:51], a[224:227], a[128:131], v[48:51]
    s_waitcnt vmcnt(14)
    v_cvt_pk_bf16_f32 v29, v30, v31
    v_cvt_pk_bf16_f32 v30, v32, v33
    v_mfma_f32_16x16x32_bf16 v[48:51], a[228:231], a[132:135], v[48:51]
    buffer_load_dwordx4 v198, s[16:19], s46 offen offset:2048 lds
    v_cvt_pk_bf16_f32 v31, v34, v35
    v_mfma_f32_16x16x32_bf16 v[56:59], a[216:219], a[136:139], v[128:131]
    ds_read_b128 a[200:203], v184 offset:16384
    ds_read_b128 a[204:207], v185 offset:16384
    v_mfma_f32_16x16x32_bf16 v[56:59], a[220:223], a[140:143], v[56:59]
    ds_read_b128 a[208:211], v186 offset:16384
    ds_read_b128 a[212:215], v187 offset:16384
    v_mfma_f32_16x16x32_bf16 v[56:59], a[224:227], a[144:147], v[56:59]
    v_exp_f32 v36, v36
    v_mfma_f32_16x16x32_bf16 v[56:59], a[228:231], a[148:151], v[56:59]
    buffer_load_dwordx4 v199, s[16:19], s46 offen offset:3072 lds
    v_mfma_f32_16x16x32_bf16 v[64:67], a[216:219], a[152:155], v[132:135]
    s_add_u32 m0, s30, 36864
    v_exp_f32 v37, v37
    v_mfma_f32_16x16x32_bf16 v[64:67], a[220:223], a[156:159], v[64:67]
    v_exp_f32 v38, v38
    v_mfma_f32_16x16x32_bf16 v[64:67], a[224:227], a[160:163], v[64:67]
    v_exp_f32 v39, v39
    v_mfma_f32_16x16x32_bf16 v[64:67], a[228:231], a[164:167], v[64:67]
    buffer_load_dwordx4 v196, s[16:19], s47 offen offset:0 lds
    v_cvt_pk_bf16_f32 v36, v36, v37
    v_mfma_f32_16x16x32_bf16 v[72:75], a[216:219], a[168:171], v[136:139]
    v_exp_f32 v40, v40
    v_mfma_f32_16x16x32_bf16 v[72:75], a[220:223], a[172:175], v[72:75]
    v_exp_f32 v41, v41
    v_mfma_f32_16x16x32_bf16 v[72:75], a[224:227], a[176:179], v[72:75]
    v_exp_f32 v42, v42
    v_mfma_f32_16x16x32_bf16 v[72:75], a[228:231], a[180:183], v[72:75]
    buffer_load_dwordx4 v197, s[16:19], s47 offen offset:1024 lds
    v_cvt_pk_bf16_f32 v37, v38, v39
    v_mfma_f32_16x16x32_bf16 v[80:83], a[216:219], a[184:187], v[140:143]
    v_exp_f32 v43, v43
    v_mfma_f32_16x16x32_bf16 v[80:83], a[220:223], a[188:191], v[80:83]
    v_cvt_pk_bf16_f32 v38, v40, v41
    v_cvt_pk_bf16_f32 v39, v42, v43
    v_mfma_f32_16x16x32_bf16 v[80:83], a[224:227], a[192:195], v[80:83]
    s_waitcnt lgkmcnt(0)
    v_exp_f32 v44, v44
    v_mfma_f32_16x16x32_bf16 v[80:83], a[228:231], a[196:199], v[80:83]
    buffer_load_dwordx4 v198, s[16:19], s47 offen offset:2048 lds
    v_mfma_f32_16x16x32_bf16 v[84:87], a[200:203], a[120:123], v[124:127]
    v_exp_f32 v45, v45
    v_mfma_f32_16x16x32_bf16 v[84:87], a[204:207], a[124:127], v[84:87]
    v_exp_f32 v46, v46
    v_mfma_f32_16x16x32_bf16 v[84:87], a[208:211], a[128:131], v[84:87]
    v_exp_f32 v47, v47
    v_mfma_f32_16x16x32_bf16 v[84:87], a[212:215], a[132:135], v[84:87]
    buffer_load_dwordx4 v199, s[16:19], s47 offen offset:3072 lds
    v_cvt_pk_bf16_f32 v44, v44, v45
    v_mfma_f32_16x16x32_bf16 v[92:95], a[200:203], a[136:139], v[128:131]
    s_add_u32 m0, s30, 0
    v_exp_f32 v48, v48
    v_mfma_f32_16x16x32_bf16 v[92:95], a[204:207], a[140:143], v[92:95]
    s_waitcnt vmcnt(16)
    ds_read_b128 a[216:219], v184 offset:20480
    ds_read_b128 a[220:223], v185 offset:20480
    v_mfma_f32_16x16x32_bf16 v[92:95], a[208:211], a[144:147], v[92:95]
    ds_read_b128 a[224:227], v186 offset:20480
    ds_read_b128 a[228:231], v187 offset:20480
    v_mfma_f32_16x16x32_bf16 v[92:95], a[212:215], a[148:151], v[92:95]
    buffer_load_dwordx4 v200, s[20:23], s42 offen offset:0 lds
    v_cvt_pk_bf16_f32 v45, v46, v47
    v_mfma_f32_16x16x32_bf16 v[100:103], a[200:203], a[152:155], v[132:135]
    v_exp_f32 v49, v49
    v_mfma_f32_16x16x32_bf16 v[100:103], a[204:207], a[156:159], v[100:103]
    v_exp_f32 v50, v50
    v_mfma_f32_16x16x32_bf16 v[100:103], a[208:211], a[160:163], v[100:103]
    v_exp_f32 v51, v51
    v_mfma_f32_16x16x32_bf16 v[100:103], a[212:215], a[164:167], v[100:103]
    buffer_load_dwordx4 v201, s[20:23], s42 offen offset:1024 lds
    v_cvt_pk_bf16_f32 v46, v48, v49
    v_mfma_f32_16x16x32_bf16 v[108:111], a[200:203], a[168:171], v[136:139]
    v_exp_f32 v52, v52
    v_mfma_f32_16x16x32_bf16 v[108:111], a[204:207], a[172:175], v[108:111]
    v_exp_f32 v53, v53
    v_mfma_f32_16x16x32_bf16 v[108:111], a[208:211], a[176:179], v[108:111]
    v_exp_f32 v54, v54
    v_mfma_f32_16x16x32_bf16 v[108:111], a[212:215], a[180:183], v[108:111]
    buffer_load_dwordx4 v200, s[20:23], s42 offen offset:2048 lds
    v_cvt_pk_bf16_f32 v47, v50, v51
    v_mfma_f32_16x16x32_bf16 v[116:119], a[200:203], a[184:187], v[140:143]
    v_exp_f32 v55, v55
    v_mfma_f32_16x16x32_bf16 v[116:119], a[204:207], a[188:191], v[116:119]
    v_exp_f32 v56, v56
    v_mfma_f32_16x16x32_bf16 v[116:119], a[208:211], a[192:195], v[116:119]
    s_waitcnt lgkmcnt(0)
    v_exp_f32 v57, v57
    v_mfma_f32_16x16x32_bf16 v[116:119], a[212:215], a[196:199], v[116:119]
    buffer_load_dwordx4 v201, s[20:23], s42 offen offset:3072 lds
    v_cvt_pk_bf16_f32 v52, v52, v53
    v_mfma_f32_16x16x32_bf16 v[88:91], a[216:219], a[120:123], v[124:127]
    s_add_u32 m0, s30, 4096
    v_exp_f32 v58, v58
    v_mfma_f32_16x16x32_bf16 v[88:91], a[220:223], a[124:127], v[88:91]
    v_exp_f32 v59, v59
    v_mfma_f32_16x16x32_bf16 v[88:91], a[224:227], a[128:131], v[88:91]
    s_waitcnt vmcnt(12)
    v_cvt_pk_bf16_f32 v53, v54, v55
    v_cvt_pk_bf16_f32 v54, v56, v57
    v_mfma_f32_16x16x32_bf16 v[88:91], a[228:231], a[132:135], v[88:91]
    buffer_load_dwordx4 v200, s[20:23], s43 offen offset:0 lds
    v_cvt_pk_bf16_f32 v55, v58, v59
    v_mfma_f32_16x16x32_bf16 v[96:99], a[216:219], a[136:139], v[128:131]
    ds_read_b64_tr_b16 v[224:225], v188 offset:24576
    ds_read_b64_tr_b16 v[226:227], v188 offset:28672
    v_mfma_f32_16x16x32_bf16 v[96:99], a[220:223], a[140:143], v[96:99]
    v_exp_f32 v60, v60
    v_mfma_f32_16x16x32_bf16 v[96:99], a[224:227], a[144:147], v[96:99]
    v_exp_f32 v61, v61
    v_mfma_f32_16x16x32_bf16 v[96:99], a[228:231], a[148:151], v[96:99]
    buffer_load_dwordx4 v201, s[20:23], s43 offen offset:1024 lds
    v_cvt_pk_bf16_f32 v60, v60, v61
    v_mfma_f32_16x16x32_bf16 v[104:107], a[216:219], a[152:155], v[132:135]
    v_exp_f32 v62, v62
    v_mfma_f32_16x16x32_bf16 v[104:107], a[220:223], a[156:159], v[104:107]
    ds_read_b64_tr_b16 v[228:229], v189 offset:24576
    ds_read_b64_tr_b16 v[230:231], v189 offset:28672
    v_mfma_f32_16x16x32_bf16 v[104:107], a[224:227], a[160:163], v[104:107]
    v_exp_f32 v63, v63
    v_mfma_f32_16x16x32_bf16 v[104:107], a[228:231], a[164:167], v[104:107]
    buffer_load_dwordx4 v200, s[20:23], s43 offen offset:2048 lds
    v_cvt_pk_bf16_f32 v61, v62, v63
    v_mfma_f32_16x16x32_bf16 v[112:115], a[216:219], a[168:171], v[136:139]
    v_exp_f32 v64, v64
    v_mfma_f32_16x16x32_bf16 v[112:115], a[220:223], a[172:175], v[112:115]
    v_exp_f32 v65, v65
    v_mfma_f32_16x16x32_bf16 v[112:115], a[224:227], a[176:179], v[112:115]
    ds_read_b64_tr_b16 v[232:233], v190 offset:24576
    ds_read_b64_tr_b16 v[234:235], v190 offset:28672
    v_mfma_f32_16x16x32_bf16 v[112:115], a[228:231], a[180:183], v[112:115]
    buffer_load_dwordx4 v201, s[20:23], s43 offen offset:3072 lds
    v_cvt_pk_bf16_f32 v62, v64, v65
    v_mfma_f32_16x16x32_bf16 v[120:123], a[216:219], a[184:187], v[140:143]
    s_add_u32 m0, s30, 8192
    v_exp_f32 v66, v66
    v_mfma_f32_16x16x32_bf16 v[120:123], a[220:223], a[188:191], v[120:123]
    v_exp_f32 v67, v67
    v_mfma_f32_16x16x32_bf16 v[120:123], a[224:227], a[192:195], v[120:123]
    s_waitcnt lgkmcnt(2)
    v_exp_f32 v68, v68
    v_mfma_f32_16x16x32_bf16 v[120:123], a[228:231], a[196:199], v[120:123]
    buffer_load_dwordx4 v196, s[16:19], s48 offen offset:0 lds
    ds_read_b64_tr_b16 v[236:237], v191 offset:24576
    v_mfma_f32_16x16x32_bf16 a[0:3], v[224:227], v[4:7], 0
    ds_read_b64_tr_b16 v[238:239], v191 offset:28672
    v_cvt_pk_bf16_f32 v63, v66, v67
    v_mfma_f32_16x16x32_bf16 a[4:7], v[224:227], v[12:15], 0
    v_exp_f32 v69, v69
    v_mfma_f32_16x16x32_bf16 a[8:11], v[224:227], v[20:23], 0
    v_exp_f32 v70, v70
    v_mfma_f32_16x16x32_bf16 a[12:15], v[224:227], v[28:31], 0
    buffer_load_dwordx4 v197, s[16:19], s48 offen offset:1024 lds
    v_cvt_pk_bf16_f32 v68, v68, v69
    v_mfma_f32_16x16x32_bf16 a[16:19], v[224:227], v[36:39], 0
    v_exp_f32 v71, v71
    v_mfma_f32_16x16x32_bf16 a[20:23], v[228:231], v[4:7], 0
    ds_read_b64_tr_b16 v[240:241], v192 offset:24576
    ds_read_b64_tr_b16 v[242:243], v192 offset:28672
    v_mfma_f32_16x16x32_bf16 a[24:27], v[228:231], v[12:15], 0
    v_exp_f32 v72, v72
    v_mfma_f32_16x16x32_bf16 a[28:31], v[228:231], v[20:23], 0
    buffer_load_dwordx4 v198, s[16:19], s48 offen offset:2048 lds
    v_cvt_pk_bf16_f32 v69, v70, v71
    v_mfma_f32_16x16x32_bf16 a[32:35], v[228:231], v[28:31], 0
    v_exp_f32 v73, v73
    v_mfma_f32_16x16x32_bf16 a[36:39], v[228:231], v[36:39], 0
    s_waitcnt lgkmcnt(2)
    v_exp_f32 v74, v74
    v_mfma_f32_16x16x32_bf16 a[40:43], v[232:235], v[4:7], 0
    v_exp_f32 v75, v75
    v_mfma_f32_16x16x32_bf16 a[44:47], v[232:235], v[12:15], 0
    buffer_load_dwordx4 v199, s[16:19], s48 offen offset:3072 lds
    ds_read_b64_tr_b16 v[244:245], v193 offset:24576
    v_mfma_f32_16x16x32_bf16 a[48:51], v[232:235], v[20:23], 0
    s_add_u32 m0, s30, 12288
    v_exp_f32 v76, v76
    v_mfma_f32_16x16x32_bf16 a[52:55], v[232:235], v[28:31], 0
    ds_read_b64_tr_b16 v[246:247], v193 offset:28672
    v_cvt_pk_bf16_f32 v70, v72, v73
    v_mfma_f32_16x16x32_bf16 a[56:59], v[232:235], v[36:39], 0
    v_exp_f32 v77, v77
    v_mfma_f32_16x16x32_bf16 a[60:63], v[236:239], v[4:7], 0
    buffer_load_dwordx4 v196, s[16:19], s49 offen offset:0 lds
    v_cvt_pk_bf16_f32 v71, v74, v75
    v_mfma_f32_16x16x32_bf16 a[64:67], v[236:239], v[12:15], 0
    v_exp_f32 v78, v78
    v_mfma_f32_16x16x32_bf16 a[68:71], v[236:239], v[20:23], 0
    ds_read_b64_tr_b16 v[248:249], v194 offset:24576
    ds_read_b64_tr_b16 v[250:251], v194 offset:28672
    v_mfma_f32_16x16x32_bf16 a[72:75], v[236:239], v[28:31], 0
    v_exp_f32 v79, v79
    v_mfma_f32_16x16x32_bf16 a[76:79], v[236:239], v[36:39], 0
    s_waitcnt lgkmcnt(3)
    v_exp_f32 v80, v80
    v_mfma_f32_16x16x32_bf16 a[232:235], a[252:255], v[4:7], 0
    buffer_load_dwordx4 v197, s[16:19], s49 offen offset:1024 lds
    v_cvt_pk_bf16_f32 v76, v76, v77
    v_mfma_f32_16x16x32_bf16 a[80:83], v[240:243], v[4:7], 0
    v_exp_f32 v81, v81
    v_mfma_f32_16x16x32_bf16 a[84:87], v[240:243], v[12:15], 0
    v_exp_f32 v82, v82
    v_mfma_f32_16x16x32_bf16 a[88:91], v[240:243], v[20:23], 0
    ds_read_b64_tr_b16 v[252:253], v195 offset:24576
    ds_read_b64_tr_b16 v[254:255], v195 offset:28672
    v_mfma_f32_16x16x32_bf16 a[92:95], v[240:243], v[28:31], 0
    v_exp_f32 v83, v83
    v_mfma_f32_16x16x32_bf16 a[96:99], v[240:243], v[36:39], 0
    buffer_load_dwordx4 v198, s[16:19], s49 offen offset:2048 lds
    v_cvt_pk_bf16_f32 v77, v78, v79
    v_mfma_f32_16x16x32_bf16 a[236:239], a[252:255], v[12:15], 0
    s_waitcnt lgkmcnt(2)
    v_cvt_pk_bf16_f32 v78, v80, v81
    v_cvt_pk_bf16_f32 v79, v82, v83
    v_mfma_f32_16x16x32_bf16 a[100:103], v[244:247], v[4:7], 0
    v_exp_f32 v84, v84
    v_mfma_f32_16x16x32_bf16 a[104:107], v[244:247], v[12:15], 0
    s_waitcnt vmcnt(19)
    v_exp_f32 v85, v85
    v_mfma_f32_16x16x32_bf16 a[108:111], v[244:247], v[20:23], 0
    ds_read_b128 a[200:203], v184 offset:32768
    ds_read_b128 a[204:207], v185 offset:32768
    v_mfma_f32_16x16x32_bf16 a[112:115], v[244:247], v[28:31], 0
    buffer_load_dwordx4 v199, s[16:19], s49 offen offset:3072 lds
    ds_read_b128 a[208:211], v186 offset:32768
    v_mfma_f32_16x16x32_bf16 a[116:119], v[244:247], v[36:39], 0
    s_add_u32 m0, s30, 16384
    v_exp_f32 v86, v86
    v_mfma_f32_16x16x32_bf16 a[240:243], a[252:255], v[20:23], 0
    ds_read_b128 a[212:215], v187 offset:32768
    v_cvt_pk_bf16_f32 v84, v84, v85
    v_mfma_f32_16x16x32_bf16 v[144:147], v[248:251], v[4:7], 0
    v_exp_f32 v87, v87
    v_mfma_f32_16x16x32_bf16 v[148:151], v[248:251], v[12:15], 0
    v_exp_f32 v88, v88
    v_mfma_f32_16x16x32_bf16 v[152:155], v[248:251], v[20:23], 0
    buffer_load_dwordx4 v200, s[20:23], s44 offen offset:0 lds
    v_cvt_pk_bf16_f32 v85, v86, v87
    v_mfma_f32_16x16x32_bf16 v[156:159], v[248:251], v[28:31], 0
    v_exp_f32 v89, v89
    v_mfma_f32_16x16x32_bf16 v[160:163], v[248:251], v[36:39], 0
    v_exp_f32 v90, v90
    v_mfma_f32_16x16x32_bf16 a[244:247], a[252:255], v[28:31], 0
    s_waitcnt lgkmcnt(1)
    v_exp_f32 v91, v91
    v_mfma_f32_16x16x32_bf16 v[164:167], v[252:255], v[4:7], 0
    v_exp_f32 v92, v92
    v_mfma_f32_16x16x32_bf16 v[168:171], v[252:255], v[12:15], 0
    buffer_load_dwordx4 v201, s[20:23], s44 offen offset:1024 lds
    v_cvt_pk_bf16_f32 v86, v88, v89
    v_mfma_f32_16x16x32_bf16 v[172:175], v[252:255], v[20:23], 0
    v_exp_f32 v93, v93
    v_mfma_f32_16x16x32_bf16 v[176:179], v[252:255], v[28:31], 0
    v_exp_f32 v94, v94
    v_mfma_f32_16x16x32_bf16 v[180:183], v[252:255], v[36:39], 0
    v_exp_f32 v95, v95
    v_mfma_f32_16x16x32_bf16 a[248:251], a[252:255], v[36:39], 0
    v_cvt_pk_bf16_f32 v87, v90, v91
    v_cvt_pk_bf16_f32 v92, v92, v93
    v_mfma_f32_16x16x32_bf16 v[4:7], a[200:203], a[120:123], v[124:127]
    buffer_load_dwordx4 v200, s[20:23], s44 offen offset:2048 lds
    v_cvt_pk_bf16_f32 v93, v94, v95
    v_mfma_f32_16x16x32_bf16 v[4:7], a[204:207], a[124:127], v[4:7]
    v_exp_f32 v96, v96
    v_mfma_f32_16x16x32_bf16 v[4:7], a[208:211], a[128:131], v[4:7]
    s_waitcnt lgkmcnt(0)
    v_exp_f32 v97, v97
    v_mfma_f32_16x16x32_bf16 v[4:7], a[212:215], a[132:135], v[4:7]
    s_waitcnt vmcnt(19)
    v_exp_f32 v98, v98
    v_mfma_f32_16x16x32_bf16 v[12:15], a[200:203], a[136:139], v[128:131]
    ds_read_b128 a[216:219], v184 offset:36864
    ds_read_b128 a[220:223], v185 offset:36864
    v_mfma_f32_16x16x32_bf16 v[12:15], a[204:207], a[140:143], v[12:15]
    buffer_load_dwordx4 v201, s[20:23], s44 offen offset:3072 lds
    ds_read_b128 a[224:227], v186 offset:36864
    v_mfma_f32_16x16x32_bf16 v[12:15], a[208:211], a[144:147], v[12:15]
    s_add_u32 m0, s30, 20480
    v_exp_f32 v99, v99
    v_mfma_f32_16x16x32_bf16 v[12:15], a[212:215], a[148:151], v[12:15]
    ds_read_b128 a[228:231], v187 offset:36864
    v_cvt_pk_bf16_f32 v94, v96, v97
    v_mfma_f32_16x16x32_bf16 v[20:23], a[200:203], a[152:155], v[132:135]
    v_exp_f32 v100, v100
    v_mfma_f32_16x16x32_bf16 v[20:23], a[204:207], a[156:159], v[20:23]
    v_exp_f32 v101, v101
    v_mfma_f32_16x16x32_bf16 v[20:23], a[208:211], a[160:163], v[20:23]
    buffer_load_dwordx4 v200, s[20:23], s45 offen offset:0 lds
    v_cvt_pk_bf16_f32 v95, v98, v99
    v_mfma_f32_16x16x32_bf16 v[20:23], a[212:215], a[164:167], v[20:23]
    v_exp_f32 v102, v102
    v_mfma_f32_16x16x32_bf16 v[28:31], a[200:203], a[168:171], v[136:139]
    v_exp_f32 v103, v103
    v_mfma_f32_16x16x32_bf16 v[28:31], a[204:207], a[172:175], v[28:31]
    v_exp_f32 v104, v104
    v_mfma_f32_16x16x32_bf16 v[28:31], a[208:211], a[176:179], v[28:31]
    v_exp_f32 v105, v105
    v_mfma_f32_16x16x32_bf16 v[28:31], a[212:215], a[180:183], v[28:31]
    buffer_load_dwordx4 v201, s[20:23], s45 offen offset:1024 lds
    v_cvt_pk_bf16_f32 v100, v100, v101
    v_mfma_f32_16x16x32_bf16 v[36:39], a[200:203], a[184:187], v[140:143]
    v_exp_f32 v106, v106
    v_mfma_f32_16x16x32_bf16 v[36:39], a[204:207], a[188:191], v[36:39]
    v_exp_f32 v107, v107
    v_mfma_f32_16x16x32_bf16 v[36:39], a[208:211], a[192:195], v[36:39]
    v_cvt_pk_bf16_f32 v101, v102, v103
    v_cvt_pk_bf16_f32 v102, v104, v105
    v_mfma_f32_16x16x32_bf16 v[36:39], a[212:215], a[196:199], v[36:39]
    s_waitcnt lgkmcnt(0)
    v_exp_f32 v108, v108
    v_mfma_f32_16x16x32_bf16 v[8:11], a[216:219], a[120:123], v[124:127]
    buffer_load_dwordx4 v200, s[20:23], s45 offen offset:2048 lds
    v_cvt_pk_bf16_f32 v103, v106, v107
    v_mfma_f32_16x16x32_bf16 v[8:11], a[220:223], a[124:127], v[8:11]
    v_exp_f32 v109, v109
    v_mfma_f32_16x16x32_bf16 v[8:11], a[224:227], a[128:131], v[8:11]
    v_exp_f32 v110, v110
    v_mfma_f32_16x16x32_bf16 v[8:11], a[228:231], a[132:135], v[8:11]
    s_waitcnt vmcnt(15)
    v_exp_f32 v111, v111
    v_mfma_f32_16x16x32_bf16 v[16:19], a[216:219], a[136:139], v[128:131]
    ds_read_b64_tr_b16 v[224:225], v188 offset:0
    ds_read_b64_tr_b16 v[226:227], v188 offset:4096
    v_mfma_f32_16x16x32_bf16 v[16:19], a[220:223], a[140:143], v[16:19]
    buffer_load_dwordx4 v201, s[20:23], s45 offen offset:3072 lds
    v_cvt_pk_bf16_f32 v108, v108, v109
    v_mfma_f32_16x16x32_bf16 v[16:19], a[224:227], a[144:147], v[16:19]
    s_add_u32 m0, s30, 24576
    v_exp_f32 v112, v112
    v_mfma_f32_16x16x32_bf16 v[16:19], a[228:231], a[148:151], v[16:19]
    v_exp_f32 v113, v113
    v_mfma_f32_16x16x32_bf16 v[24:27], a[216:219], a[152:155], v[132:135]
    v_exp_f32 v114, v114
    v_mfma_f32_16x16x32_bf16 v[24:27], a[220:223], a[156:159], v[24:27]
    ds_read_b64_tr_b16 v[228:229], v189 offset:0
    ds_read_b64_tr_b16 v[230:231], v189 offset:4096
    v_mfma_f32_16x16x32_bf16 v[24:27], a[224:227], a[160:163], v[24:27]
    buffer_load_dwordx4 v196, s[16:19], s50 offen offset:0 lds
    v_cvt_pk_bf16_f32 v109, v110, v111
    v_mfma_f32_16x16x32_bf16 v[24:27], a[228:231], a[164:167], v[24:27]
    v_exp_f32 v115, v115
    v_mfma_f32_16x16x32_bf16 v[32:35], a[216:219], a[168:171], v[136:139]
    v_exp_f32 v116, v116
    v_mfma_f32_16x16x32_bf16 v[32:35], a[220:223], a[172:175], v[32:35]
    v_exp_f32 v117, v117
    v_mfma_f32_16x16x32_bf16 v[32:35], a[224:227], a[176:179], v[32:35]
    ds_read_b64_tr_b16 v[232:233], v190 offset:0
    ds_read_b64_tr_b16 v[234:235], v190 offset:4096
    v_mfma_f32_16x16x32_bf16 v[32:35], a[228:231], a[180:183], v[32:35]
    buffer_load_dwordx4 v197, s[16:19], s50 offen offset:1024 lds
    v_cvt_pk_bf16_f32 v110, v112, v113
    v_mfma_f32_16x16x32_bf16 v[40:43], a[216:219], a[184:187], v[140:143]
    v_exp_f32 v118, v118
    v_mfma_f32_16x16x32_bf16 v[40:43], a[220:223], a[188:191], v[40:43]
    v_exp_f32 v119, v119
    v_mfma_f32_16x16x32_bf16 v[40:43], a[224:227], a[192:195], v[40:43]
    s_waitcnt lgkmcnt(2)
    v_cvt_pk_bf16_f32 v111, v114, v115
    v_cvt_pk_bf16_f32 v116, v116, v117
    v_mfma_f32_16x16x32_bf16 v[40:43], a[228:231], a[196:199], v[40:43]
    ds_read_b64_tr_b16 v[236:237], v191 offset:0
    ds_read_b64_tr_b16 v[238:239], v191 offset:4096
    v_mfma_f32_16x16x32_bf16 a[0:3], v[224:227], v[44:47], a[0:3]
    buffer_load_dwordx4 v198, s[16:19], s50 offen offset:2048 lds
    v_cvt_pk_bf16_f32 v117, v118, v119
    v_mfma_f32_16x16x32_bf16 a[4:7], v[224:227], v[52:55], a[4:7]
    v_exp_f32 v120, v120
    v_mfma_f32_16x16x32_bf16 a[8:11], v[224:227], v[60:63], a[8:11]
    v_exp_f32 v121, v121
    v_mfma_f32_16x16x32_bf16 a[12:15], v[224:227], v[68:71], a[12:15]
    v_exp_f32 v122, v122
    v_mfma_f32_16x16x32_bf16 a[16:19], v[224:227], v[76:79], a[16:19]
    v_exp_f32 v123, v123
    v_mfma_f32_16x16x32_bf16 a[20:23], v[228:231], v[44:47], a[20:23]
    buffer_load_dwordx4 v199, s[16:19], s50 offen offset:3072 lds
    ds_read_b64_tr_b16 v[240:241], v192 offset:0
    v_mfma_f32_16x16x32_bf16 a[24:27], v[228:231], v[52:55], a[24:27]
    s_add_u32 m0, s30, 28672
    v_cvt_pk_bf16_f32 v118, v120, v121
    v_cvt_pk_bf16_f32 v119, v122, v123
    v_mfma_f32_16x16x32_bf16 a[28:31], v[228:231], v[60:63], a[28:31]
    v_exp_f32 v4, v4
    v_mfma_f32_16x16x32_bf16 a[32:35], v[228:231], v[68:71], a[32:35]
    s_waitcnt lgkmcnt(1)
    v_exp_f32 v5, v5
    v_mfma_f32_16x16x32_bf16 a[36:39], v[228:231], v[76:79], a[36:39]
    ds_read_b64_tr_b16 v[242:243], v192 offset:4096
    v_cvt_pk_bf16_f32 v4, v4, v5
    v_mfma_f32_16x16x32_bf16 a[40:43], v[232:235], v[44:47], a[40:43]
    buffer_load_dwordx4 v196, s[16:19], s51 offen offset:0 lds
    v_mfma_f32_16x16x32_bf16 a[44:47], v[232:235], v[52:55], a[44:47]
    ds_read_b64_tr_b16 v[244:245], v193 offset:0
    ds_read_b64_tr_b16 v[246:247], v193 offset:4096
    v_mfma_f32_16x16x32_bf16 a[48:51], v[232:235], v[60:63], a[48:51]
    v_exp_f32 v6, v6
    v_mfma_f32_16x16x32_bf16 a[52:55], v[232:235], v[68:71], a[52:55]
    v_exp_f32 v7, v7
    v_mfma_f32_16x16x32_bf16 a[56:59], v[232:235], v[76:79], a[56:59]
    v_exp_f32 v8, v8
    v_mfma_f32_16x16x32_bf16 a[60:63], v[236:239], v[44:47], a[60:63]
    buffer_load_dwordx4 v197, s[16:19], s51 offen offset:1024 lds
    v_cvt_pk_bf16_f32 v5, v6, v7
    v_mfma_f32_16x16x32_bf16 a[64:67], v[236:239], v[52:55], a[64:67]
    v_exp_f32 v9, v9
    v_mfma_f32_16x16x32_bf16 a[68:71], v[236:239], v[60:63], a[68:71]
    ds_read_b64_tr_b16 v[248:249], v194 offset:0
    ds_read_b64_tr_b16 v[250:251], v194 offset:4096
    v_mfma_f32_16x16x32_bf16 a[72:75], v[236:239], v[68:71], a[72:75]
    v_exp_f32 v10, v10
    v_mfma_f32_16x16x32_bf16 a[76:79], v[236:239], v[76:79], a[76:79]
    s_waitcnt lgkmcnt(2)
    v_exp_f32 v11, v11
    v_mfma_f32_16x16x32_bf16 a[232:235], a[252:255], v[44:47], a[232:235]
    buffer_load_dwordx4 v198, s[16:19], s51 offen offset:2048 lds
    v_cvt_pk_bf16_f32 v6, v8, v9
    v_mfma_f32_16x16x32_bf16 a[80:83], v[240:243], v[44:47], a[80:83]
    v_exp_f32 v12, v12
    v_mfma_f32_16x16x32_bf16 a[84:87], v[240:243], v[52:55], a[84:87]
    v_exp_f32 v13, v13
    v_mfma_f32_16x16x32_bf16 a[88:91], v[240:243], v[60:63], a[88:91]
    ds_read_b64_tr_b16 v[252:253], v195 offset:0
    ds_read_b64_tr_b16 v[254:255], v195 offset:4096
    v_mfma_f32_16x16x32_bf16 a[92:95], v[240:243], v[68:71], a[92:95]
    v_exp_f32 v14, v14
    v_mfma_f32_16x16x32_bf16 a[96:99], v[240:243], v[76:79], a[96:99]
    buffer_load_dwordx4 v199, s[16:19], s51 offen offset:3072 lds
    v_cvt_pk_bf16_f32 v7, v10, v11
    v_mfma_f32_16x16x32_bf16 a[236:239], a[252:255], v[52:55], a[236:239]
    s_add_u32 m0, s30, 32768
    v_exp_f32 v15, v15
    v_mfma_f32_16x16x32_bf16 a[100:103], v[244:247], v[44:47], a[100:103]
    v_exp_f32 v16, v16
    v_mfma_f32_16x16x32_bf16 a[104:107], v[244:247], v[52:55], a[104:107]
    s_waitcnt vmcnt(20) lgkmcnt(2)
    v_exp_f32 v17, v17
    v_mfma_f32_16x16x32_bf16 a[108:111], v[244:247], v[60:63], a[108:111]
    ds_read_b128 a[200:203], v184 offset:8192
    ds_read_b128 a[204:207], v185 offset:8192
    v_mfma_f32_16x16x32_bf16 a[112:115], v[244:247], v[68:71], a[112:115]
    buffer_load_dwordx4 v200, s[20:23], s46 offen offset:0 lds
    ds_read_b128 a[208:211], v186 offset:8192
    v_mfma_f32_16x16x32_bf16 a[116:119], v[244:247], v[76:79], a[116:119]
    ds_read_b128 a[212:215], v187 offset:8192
    v_cvt_pk_bf16_f32 v12, v12, v13
    v_mfma_f32_16x16x32_bf16 a[240:243], a[252:255], v[60:63], a[240:243]
    v_exp_f32 v18, v18
    v_mfma_f32_16x16x32_bf16 v[144:147], v[248:251], v[44:47], v[144:147]
    v_exp_f32 v19, v19
    v_mfma_f32_16x16x32_bf16 v[148:151], v[248:251], v[52:55], v[148:151]
    v_cvt_pk_bf16_f32 v13, v14, v15
    v_cvt_pk_bf16_f32 v14, v16, v17
    v_mfma_f32_16x16x32_bf16 v[152:155], v[248:251], v[60:63], v[152:155]
    buffer_load_dwordx4 v201, s[20:23], s46 offen offset:1024 lds
    v_cvt_pk_bf16_f32 v15, v18, v19
    v_mfma_f32_16x16x32_bf16 v[156:159], v[248:251], v[68:71], v[156:159]
    v_exp_f32 v20, v20
    v_mfma_f32_16x16x32_bf16 v[160:163], v[248:251], v[76:79], v[160:163]
    v_exp_f32 v21, v21
    v_mfma_f32_16x16x32_bf16 a[244:247], a[252:255], v[68:71], a[244:247]
    s_waitcnt lgkmcnt(0)
    v_exp_f32 v22, v22
    v_mfma_f32_16x16x32_bf16 v[164:167], v[252:255], v[44:47], v[164:167]
    v_exp_f32 v23, v23
    v_mfma_f32_16x16x32_bf16 v[168:171], v[252:255], v[52:55], v[168:171]
    buffer_load_dwordx4 v200, s[20:23], s46 offen offset:2048 lds
    v_cvt_pk_bf16_f32 v20, v20, v21
    v_mfma_f32_16x16x32_bf16 v[172:175], v[252:255], v[60:63], v[172:175]
    v_exp_f32 v24, v24
    v_mfma_f32_16x16x32_bf16 v[176:179], v[252:255], v[68:71], v[176:179]
    v_exp_f32 v25, v25
    v_mfma_f32_16x16x32_bf16 v[180:183], v[252:255], v[76:79], v[180:183]
    v_exp_f32 v26, v26
    v_mfma_f32_16x16x32_bf16 a[248:251], a[252:255], v[76:79], a[248:251]
    v_exp_f32 v27, v27
    v_mfma_f32_16x16x32_bf16 v[44:47], a[200:203], a[120:123], v[124:127]
    buffer_load_dwordx4 v201, s[20:23], s46 offen offset:3072 lds
    v_cvt_pk_bf16_f32 v21, v22, v23
    v_mfma_f32_16x16x32_bf16 v[44:47], a[204:207], a[124:127], v[44:47]
    s_add_u32 m0, s30, 36864
    v_exp_f32 v28, v28
    v_mfma_f32_16x16x32_bf16 v[44:47], a[208:211], a[128:131], v[44:47]
    v_exp_f32 v29, v29
    v_mfma_f32_16x16x32_bf16 v[44:47], a[212:215], a[132:135], v[44:47]
    s_waitcnt vmcnt(20)
    v_exp_f32 v30, v30
    v_mfma_f32_16x16x32_bf16 v[52:55], a[200:203], a[136:139], v[128:131]
    ds_read_b128 a[216:219], v184 offset:12288
    ds_read_b128 a[220:223], v185 offset:12288
    v_mfma_f32_16x16x32_bf16 v[52:55], a[204:207], a[140:143], v[52:55]
    buffer_load_dwordx4 v200, s[20:23], s47 offen offset:0 lds
    ds_read_b128 a[224:227], v186 offset:12288
    v_mfma_f32_16x16x32_bf16 v[52:55], a[208:211], a[144:147], v[52:55]
    ds_read_b128 a[228:231], v187 offset:12288
    v_cvt_pk_bf16_f32 v22, v24, v25
    v_mfma_f32_16x16x32_bf16 v[52:55], a[212:215], a[148:151], v[52:55]
    v_exp_f32 v31, v31
    v_mfma_f32_16x16x32_bf16 v[60:63], a[200:203], a[152:155], v[132:135]
    v_cvt_pk_bf16_f32 v23, v26, v27
    v_cvt_pk_bf16_f32 v28, v28, v29
    v_mfma_f32_16x16x32_bf16 v[60:63], a[204:207], a[156:159], v[60:63]
    v_exp_f32 v32, v32
    v_mfma_f32_16x16x32_bf16 v[60:63], a[208:211], a[160:163], v[60:63]
    buffer_load_dwordx4 v201, s[20:23], s47 offen offset:1024 lds
    v_cvt_pk_bf16_f32 v29, v30, v31
    v_mfma_f32_16x16x32_bf16 v[60:63], a[212:215], a[164:167], v[60:63]
    v_exp_f32 v33, v33
    v_mfma_f32_16x16x32_bf16 v[68:71], a[200:203], a[168:171], v[136:139]
    v_exp_f32 v34, v34
    v_mfma_f32_16x16x32_bf16 v[68:71], a[204:207], a[172:175], v[68:71]
    v_exp_f32 v35, v35
    v_mfma_f32_16x16x32_bf16 v[68:71], a[208:211], a[176:179], v[68:71]
    v_exp_f32 v36, v36
    v_mfma_f32_16x16x32_bf16 v[68:71], a[212:215], a[180:183], v[68:71]
    buffer_load_dwordx4 v200, s[20:23], s47 offen offset:2048 lds
    v_cvt_pk_bf16_f32 v30, v32, v33
    v_mfma_f32_16x16x32_bf16 v[76:79], a[200:203], a[184:187], v[140:143]
    v_exp_f32 v37, v37
    v_mfma_f32_16x16x32_bf16 v[76:79], a[204:207], a[188:191], v[76:79]
    v_exp_f32 v38, v38
    v_mfma_f32_16x16x32_bf16 v[76:79], a[208:211], a[192:195], v[76:79]
    v_exp_f32 v39, v39
    v_mfma_f32_16x16x32_bf16 v[76:79], a[212:215], a[196:199], v[76:79]
    s_waitcnt lgkmcnt(0)
    v_cvt_pk_bf16_f32 v31, v34, v35
    v_cvt_pk_bf16_f32 v36, v36, v37
    v_mfma_f32_16x16x32_bf16 v[48:51], a[216:219], a[120:123], v[124:127]
    buffer_load_dwordx4 v201, s[20:23], s47 offen offset:3072 lds
    v_cvt_pk_bf16_f32 v37, v38, v39
    v_mfma_f32_16x16x32_bf16 v[48:51], a[220:223], a[124:127], v[48:51]
    s_add_u32 m0, s30, 0
    v_exp_f32 v40, v40
    v_mfma_f32_16x16x32_bf16 v[48:51], a[224:227], a[128:131], v[48:51]
    v_exp_f32 v41, v41
    v_mfma_f32_16x16x32_bf16 v[48:51], a[228:231], a[132:135], v[48:51]
    s_waitcnt vmcnt(16)
    v_exp_f32 v42, v42
    v_mfma_f32_16x16x32_bf16 v[56:59], a[216:219], a[136:139], v[128:131]
    ds_read_b64_tr_b16 v[224:225], v188 offset:16384
    ds_read_b64_tr_b16 v[226:227], v188 offset:20480
    v_mfma_f32_16x16x32_bf16 v[56:59], a[220:223], a[140:143], v[56:59]
    buffer_load_dwordx4 v196, s[16:19], s52 offen offset:0 lds
    v_cvt_pk_bf16_f32 v38, v40, v41
    v_mfma_f32_16x16x32_bf16 v[56:59], a[224:227], a[144:147], v[56:59]
    v_exp_f32 v43, v43
    v_mfma_f32_16x16x32_bf16 v[56:59], a[228:231], a[148:151], v[56:59]
    v_cvt_pk_bf16_f32 v39, v42, v43
    v_mfma_f32_16x16x32_bf16 v[64:67], a[216:219], a[152:155], v[132:135]
    v_exp_f32 v44, v44
    v_mfma_f32_16x16x32_bf16 v[64:67], a[220:223], a[156:159], v[64:67]
    ds_read_b64_tr_b16 v[228:229], v189 offset:16384
    ds_read_b64_tr_b16 v[230:231], v189 offset:20480
    v_mfma_f32_16x16x32_bf16 v[64:67], a[224:227], a[160:163], v[64:67]
    buffer_load_dwordx4 v197, s[16:19], s52 offen offset:1024 lds
    v_mfma_f32_16x16x32_bf16 v[64:67], a[228:231], a[164:167], v[64:67]
    v_exp_f32 v45, v45
    v_mfma_f32_16x16x32_bf16 v[72:75], a[216:219], a[168:171], v[136:139]
    v_exp_f32 v46, v46
    v_mfma_f32_16x16x32_bf16 v[72:75], a[220:223], a[172:175], v[72:75]
    v_exp_f32 v47, v47
    v_mfma_f32_16x16x32_bf16 v[72:75], a[224:227], a[176:179], v[72:75]
    ds_read_b64_tr_b16 v[232:233], v190 offset:16384
    ds_read_b64_tr_b16 v[234:235], v190 offset:20480
    v_mfma_f32_16x16x32_bf16 v[72:75], a[228:231], a[180:183], v[72:75]
    buffer_load_dwordx4 v198, s[16:19], s52 offen offset:2048 lds
    v_cvt_pk_bf16_f32 v44, v44, v45
    v_mfma_f32_16x16x32_bf16 v[80:83], a[216:219], a[184:187], v[140:143]
    v_exp_f32 v48, v48
    v_mfma_f32_16x16x32_bf16 v[80:83], a[220:223], a[188:191], v[80:83]
    v_exp_f32 v49, v49
    v_mfma_f32_16x16x32_bf16 v[80:83], a[224:227], a[192:195], v[80:83]
    s_waitcnt lgkmcnt(2)
    v_exp_f32 v50, v50
    v_mfma_f32_16x16x32_bf16 v[80:83], a[228:231], a[196:199], v[80:83]
    ds_read_b64_tr_b16 v[236:237], v191 offset:16384
    ds_read_b64_tr_b16 v[238:239], v191 offset:20480
    v_mfma_f32_16x16x32_bf16 a[0:3], v[224:227], v[84:87], a[0:3]
    buffer_load_dwordx4 v199, s[16:19], s52 offen offset:3072 lds
    v_cvt_pk_bf16_f32 v45, v46, v47
    v_mfma_f32_16x16x32_bf16 a[4:7], v[224:227], v[92:95], a[4:7]
    s_add_u32 m0, s30, 4096
    v_exp_f32 v51, v51
    v_mfma_f32_16x16x32_bf16 a[8:11], v[224:227], v[100:103], a[8:11]
    v_exp_f32 v52, v52
    v_mfma_f32_16x16x32_bf16 a[12:15], v[224:227], v[108:111], a[12:15]
    v_exp_f32 v53, v53
    v_mfma_f32_16x16x32_bf16 a[16:19], v[224:227], v[116:119], a[16:19]
    v_exp_f32 v54, v54
    v_mfma_f32_16x16x32_bf16 a[20:23], v[228:231], v[84:87], a[20:23]
    buffer_load_dwordx4 v196, s[16:19], s53 offen offset:0 lds
    ds_read_b64_tr_b16 v[240:241], v192 offset:16384
    v_mfma_f32_16x16x32_bf16 a[24:27], v[228:231], v[92:95], a[24:27]
    ds_read_b64_tr_b16 v[242:243], v192 offset:20480
    v_cvt_pk_bf16_f32 v46, v48, v49
    v_mfma_f32_16x16x32_bf16 a[28:31], v[228:231], v[100:103], a[28:31]
    v_exp_f32 v55, v55
    v_mfma_f32_16x16x32_bf16 a[32:35], v[228:231], v[108:111], a[32:35]
    v_cvt_pk_bf16_f32 v47, v50, v51
    v_cvt_pk_bf16_f32 v52, v52, v53
    v_mfma_f32_16x16x32_bf16 a[36:39], v[228:231], v[116:119], a[36:39]
    s_waitcnt lgkmcnt(2)
    v_exp_f32 v56, v56
    v_mfma_f32_16x16x32_bf16 a[40:43], v[232:235], v[84:87], a[40:43]
    buffer_load_dwordx4 v197, s[16:19], s53 offen offset:1024 lds
    v_cvt_pk_bf16_f32 v53, v54, v55
    v_mfma_f32_16x16x32_bf16 a[44:47], v[232:235], v[92:95], a[44:47]
    ds_read_b64_tr_b16 v[244:245], v193 offset:16384
    ds_read_b64_tr_b16 v[246:247], v193 offset:20480
    v_mfma_f32_16x16x32_bf16 a[48:51], v[232:235], v[100:103], a[48:51]
    v_exp_f32 v57, v57
    v_mfma_f32_16x16x32_bf16 a[52:55], v[232:235], v[108:111], a[52:55]
    v_exp_f32 v58, v58
    v_mfma_f32_16x16x32_bf16 a[56:59], v[232:235], v[116:119], a[56:59]
    v_exp_f32 v59, v59
    v_mfma_f32_16x16x32_bf16 a[60:63], v[236:239], v[84:87], a[60:63]
    buffer_load_dwordx4 v198, s[16:19], s53 offen offset:2048 lds
    v_cvt_pk_bf16_f32 v54, v56, v57
    v_mfma_f32_16x16x32_bf16 a[64:67], v[236:239], v[92:95], a[64:67]
    v_exp_f32 v60, v60
    v_mfma_f32_16x16x32_bf16 a[68:71], v[236:239], v[100:103], a[68:71]
    ds_read_b64_tr_b16 v[248:249], v194 offset:16384
    ds_read_b64_tr_b16 v[250:251], v194 offset:20480
    v_mfma_f32_16x16x32_bf16 a[72:75], v[236:239], v[108:111], a[72:75]
    v_exp_f32 v61, v61
    v_mfma_f32_16x16x32_bf16 a[76:79], v[236:239], v[116:119], a[76:79]
    s_waitcnt lgkmcnt(2)
    v_exp_f32 v62, v62
    v_mfma_f32_16x16x32_bf16 a[232:235], a[252:255], v[84:87], a[232:235]
    buffer_load_dwordx4 v199, s[16:19], s53 offen offset:3072 lds
    v_cvt_pk_bf16_f32 v55, v58, v59
    v_mfma_f32_16x16x32_bf16 a[80:83], v[240:243], v[84:87], a[80:83]
    s_add_u32 m0, s30, 8192
    v_exp_f32 v63, v63
    v_mfma_f32_16x16x32_bf16 a[84:87], v[240:243], v[92:95], a[84:87]
    v_exp_f32 v64, v64
    v_mfma_f32_16x16x32_bf16 a[88:91], v[240:243], v[100:103], a[88:91]
    ds_read_b64_tr_b16 v[252:253], v195 offset:16384
    ds_read_b64_tr_b16 v[254:255], v195 offset:20480
    v_mfma_f32_16x16x32_bf16 a[92:95], v[240:243], v[108:111], a[92:95]
    v_exp_f32 v65, v65
    v_mfma_f32_16x16x32_bf16 a[96:99], v[240:243], v[116:119], a[96:99]
    buffer_load_dwordx4 v200, s[20:23], s48 offen offset:0 lds
    v_cvt_pk_bf16_f32 v60, v60, v61
    v_mfma_f32_16x16x32_bf16 a[236:239], a[252:255], v[92:95], a[236:239]
    v_exp_f32 v66, v66
    v_mfma_f32_16x16x32_bf16 a[100:103], v[244:247], v[84:87], a[100:103]
    v_exp_f32 v67, v67
    v_mfma_f32_16x16x32_bf16 a[104:107], v[244:247], v[92:95], a[104:107]
    s_waitcnt vmcnt(21) lgkmcnt(2)
    v_cvt_pk_bf16_f32 v61, v62, v63
    v_cvt_pk_bf16_f32 v62, v64, v65
    v_mfma_f32_16x16x32_bf16 a[108:111], v[244:247], v[100:103], a[108:111]
    ds_read_b128 a[200:203], v184 offset:24576
    ds_read_b128 a[204:207], v185 offset:24576
    v_mfma_f32_16x16x32_bf16 a[112:115], v[244:247], v[108:111], a[112:115]
    buffer_load_dwordx4 v201, s[20:23], s48 offen offset:1024 lds
    ds_read_b128 a[208:211], v186 offset:24576
    v_mfma_f32_16x16x32_bf16 a[116:119], v[244:247], v[116:119], a[116:119]
    ds_read_b128 a[212:215], v187 offset:24576
    v_cvt_pk_bf16_f32 v63, v66, v67
    v_mfma_f32_16x16x32_bf16 a[240:243], a[252:255], v[100:103], a[240:243]
    v_exp_f32 v68, v68
    v_mfma_f32_16x16x32_bf16 v[144:147], v[248:251], v[84:87], v[144:147]
    v_exp_f32 v69, v69
    v_mfma_f32_16x16x32_bf16 v[148:151], v[248:251], v[92:95], v[148:151]
    v_exp_f32 v70, v70
    v_mfma_f32_16x16x32_bf16 v[152:155], v[248:251], v[100:103], v[152:155]
    buffer_load_dwordx4 v200, s[20:23], s48 offen offset:2048 lds
    v_cvt_pk_bf16_f32 v68, v68, v69
    v_mfma_f32_16x16x32_bf16 v[156:159], v[248:251], v[108:111], v[156:159]
    v_exp_f32 v71, v71
    v_mfma_f32_16x16x32_bf16 v[160:163], v[248:251], v[116:119], v[160:163]
    v_exp_f32 v72, v72
    v_mfma_f32_16x16x32_bf16 a[244:247], a[252:255], v[108:111], a[244:247]
    s_waitcnt lgkmcnt(0)
    v_exp_f32 v73, v73
    v_mfma_f32_16x16x32_bf16 v[164:167], v[252:255], v[84:87], v[164:167]
    v_exp_f32 v74, v74
    v_mfma_f32_16x16x32_bf16 v[168:171], v[252:255], v[92:95], v[168:171]
    buffer_load_dwordx4 v201, s[20:23], s48 offen offset:3072 lds
    v_cvt_pk_bf16_f32 v69, v70, v71
    v_mfma_f32_16x16x32_bf16 v[172:175], v[252:255], v[100:103], v[172:175]
    s_add_u32 m0, s30, 12288
    v_exp_f32 v75, v75
    v_mfma_f32_16x16x32_bf16 v[176:179], v[252:255], v[108:111], v[176:179]
    v_exp_f32 v76, v76
    v_mfma_f32_16x16x32_bf16 v[180:183], v[252:255], v[116:119], v[180:183]
    v_exp_f32 v77, v77
    v_mfma_f32_16x16x32_bf16 a[248:251], a[252:255], v[116:119], a[248:251]
    v_exp_f32 v78, v78
    v_mfma_f32_16x16x32_bf16 v[84:87], a[200:203], a[120:123], v[124:127]
    buffer_load_dwordx4 v200, s[20:23], s49 offen offset:0 lds
    v_cvt_pk_bf16_f32 v70, v72, v73
    v_mfma_f32_16x16x32_bf16 v[84:87], a[204:207], a[124:127], v[84:87]
    v_exp_f32 v79, v79
    v_mfma_f32_16x16x32_bf16 v[84:87], a[208:211], a[128:131], v[84:87]
    v_cvt_pk_bf16_f32 v71, v74, v75
    v_cvt_pk_bf16_f32 v76, v76, v77
    v_mfma_f32_16x16x32_bf16 v[84:87], a[212:215], a[132:135], v[84:87]
    s_waitcnt vmcnt(21)
    v_exp_f32 v80, v80
    v_mfma_f32_16x16x32_bf16 v[92:95], a[200:203], a[136:139], v[128:131]
    ds_read_b128 a[216:219], v184 offset:28672
    ds_read_b128 a[220:223], v185 offset:28672
    v_mfma_f32_16x16x32_bf16 v[92:95], a[204:207], a[140:143], v[92:95]
    buffer_load_dwordx4 v201, s[20:23], s49 offen offset:1024 lds
    ds_read_b128 a[224:227], v186 offset:28672
    v_mfma_f32_16x16x32_bf16 v[92:95], a[208:211], a[144:147], v[92:95]
    ds_read_b128 a[228:231], v187 offset:28672
    v_cvt_pk_bf16_f32 v77, v78, v79
    v_mfma_f32_16x16x32_bf16 v[92:95], a[212:215], a[148:151], v[92:95]
    v_exp_f32 v81, v81
    v_mfma_f32_16x16x32_bf16 v[100:103], a[200:203], a[152:155], v[132:135]
    v_exp_f32 v82, v82
    v_mfma_f32_16x16x32_bf16 v[100:103], a[204:207], a[156:159], v[100:103]
    v_exp_f32 v83, v83
    v_mfma_f32_16x16x32_bf16 v[100:103], a[208:211], a[160:163], v[100:103]
    buffer_load_dwordx4 v200, s[20:23], s49 offen offset:2048 lds
    v_cvt_pk_bf16_f32 v78, v80, v81
    v_mfma_f32_16x16x32_bf16 v[100:103], a[212:215], a[164:167], v[100:103]
    v_cvt_pk_bf16_f32 v79, v82, v83
    v_mfma_f32_16x16x32_bf16 v[108:111], a[200:203], a[168:171], v[136:139]
    v_exp_f32 v84, v84
    v_mfma_f32_16x16x32_bf16 v[108:111], a[204:207], a[172:175], v[108:111]
    v_exp_f32 v85, v85
    v_mfma_f32_16x16x32_bf16 v[108:111], a[208:211], a[176:179], v[108:111]
    v_exp_f32 v86, v86
    v_mfma_f32_16x16x32_bf16 v[108:111], a[212:215], a[180:183], v[108:111]
    buffer_load_dwordx4 v201, s[20:23], s49 offen offset:3072 lds
    v_cvt_pk_bf16_f32 v84, v84, v85
    v_mfma_f32_16x16x32_bf16 v[116:119], a[200:203], a[184:187], v[140:143]
    s_add_u32 m0, s30, 16384
    v_exp_f32 v87, v87
    v_mfma_f32_16x16x32_bf16 v[116:119], a[204:207], a[188:191], v[116:119]
    v_cvt_pk_bf16_f32 v85, v86, v87
    v_mfma_f32_16x16x32_bf16 v[116:119], a[208:211], a[192:195], v[116:119]
    v_exp_f32 v92, v92
    v_mfma_f32_16x16x32_bf16 v[116:119], a[212:215], a[196:199], v[116:119]
    s_waitcnt lgkmcnt(0)
    v_exp_f32 v93, v93
    v_mfma_f32_16x16x32_bf16 v[88:91], a[216:219], a[120:123], v[124:127]
    buffer_load_dwordx4 v196, s[16:19], s54 offen offset:0 lds
    v_cvt_pk_bf16_f32 v92, v92, v93
    v_mfma_f32_16x16x32_bf16 v[88:91], a[220:223], a[124:127], v[88:91]
    v_exp_f32 v94, v94
    v_mfma_f32_16x16x32_bf16 v[88:91], a[224:227], a[128:131], v[88:91]
    v_exp_f32 v95, v95
    v_mfma_f32_16x16x32_bf16 v[88:91], a[228:231], a[132:135], v[88:91]
    s_waitcnt vmcnt(17)
    v_cvt_pk_bf16_f32 v93, v94, v95
    v_mfma_f32_16x16x32_bf16 v[96:99], a[216:219], a[136:139], v[128:131]
    ds_read_b64_tr_b16 v[224:225], v188 offset:32768
    ds_read_b64_tr_b16 v[226:227], v188 offset:36864
    v_mfma_f32_16x16x32_bf16 v[96:99], a[220:223], a[140:143], v[96:99]
    buffer_load_dwordx4 v197, s[16:19], s54 offen offset:1024 lds
    v_mfma_f32_16x16x32_bf16 v[96:99], a[224:227], a[144:147], v[96:99]
    v_exp_f32 v100, v100
    v_mfma_f32_16x16x32_bf16 v[96:99], a[228:231], a[148:151], v[96:99]
    v_exp_f32 v88, v88
    v_mfma_f32_16x16x32_bf16 v[104:107], a[216:219], a[152:155], v[132:135]
    v_exp_f32 v89, v89
    v_mfma_f32_16x16x32_bf16 v[104:107], a[220:223], a[156:159], v[104:107]
    ds_read_b64_tr_b16 v[228:229], v189 offset:32768
    ds_read_b64_tr_b16 v[230:231], v189 offset:36864
    v_mfma_f32_16x16x32_bf16 v[104:107], a[224:227], a[160:163], v[104:107]
    buffer_load_dwordx4 v198, s[16:19], s54 offen offset:2048 lds
    v_cvt_pk_bf16_f32 v86, v88, v89
    v_mfma_f32_16x16x32_bf16 v[104:107], a[228:231], a[164:167], v[104:107]
    v_exp_f32 v90, v90
    v_mfma_f32_16x16x32_bf16 v[112:115], a[216:219], a[168:171], v[136:139]
    v_exp_f32 v91, v91
    v_mfma_f32_16x16x32_bf16 v[112:115], a[220:223], a[172:175], v[112:115]
    v_cvt_pk_bf16_f32 v87, v90, v91
    v_mfma_f32_16x16x32_bf16 v[112:115], a[224:227], a[176:179], v[112:115]
    ds_read_b64_tr_b16 v[232:233], v190 offset:32768
    ds_read_b64_tr_b16 v[234:235], v190 offset:36864
    v_mfma_f32_16x16x32_bf16 v[112:115], a[228:231], a[180:183], v[112:115]
    buffer_load_dwordx4 v199, s[16:19], s54 offen offset:3072 lds
    v_mfma_f32_16x16x32_bf16 v[120:123], a[216:219], a[184:187], v[140:143]
    s_add_u32 m0, s30, 20480
    v_exp_f32 v96, v96
    v_mfma_f32_16x16x32_bf16 v[120:123], a[220:223], a[188:191], v[120:123]
    v_exp_f32 v97, v97
    v_mfma_f32_16x16x32_bf16 v[120:123], a[224:227], a[192:195], v[120:123]
    s_waitcnt lgkmcnt(2)
    v_exp_f32 v98, v98
    v_mfma_f32_16x16x32_bf16 v[120:123], a[228:231], a[196:199], v[120:123]
    ds_read_b64_tr_b16 v[236:237], v191 offset:32768
    ds_read_b64_tr_b16 v[238:239], v191 offset:36864
    v_mfma_f32_16x16x32_bf16 a[0:3], v[224:227], v[4:7], a[0:3]
    buffer_load_dwordx4 v196, s[16:19], s55 offen offset:0 lds
    v_cvt_pk_bf16_f32 v94, v96, v97
    v_mfma_f32_16x16x32_bf16 a[4:7], v[224:227], v[12:15], a[4:7]
    v_exp_f32 v99, v99
    v_mfma_f32_16x16x32_bf16 a[8:11], v[224:227], v[20:23], a[8:11]
    v_cvt_pk_bf16_f32 v95, v98, v99
    v_mfma_f32_16x16x32_bf16 a[12:15], v[224:227], v[28:31], a[12:15]
    v_exp_f32 v101, v101
    v_mfma_f32_16x16x32_bf16 a[16:19], v[224:227], v[36:39], a[16:19]
    v_exp_f32 v102, v102
    v_mfma_f32_16x16x32_bf16 a[20:23], v[228:231], v[4:7], a[20:23]
    buffer_load_dwordx4 v197, s[16:19], s55 offen offset:1024 lds
    ds_read_b64_tr_b16 v[240:241], v192 offset:32768
    v_mfma_f32_16x16x32_bf16 a[24:27], v[228:231], v[12:15], a[24:27]
    ds_read_b64_tr_b16 v[242:243], v192 offset:36864
    v_cvt_pk_bf16_f32 v100, v100, v101
    v_mfma_f32_16x16x32_bf16 a[28:31], v[228:231], v[20:23], a[28:31]
    v_exp_f32 v103, v103
    v_mfma_f32_16x16x32_bf16 a[32:35], v[228:231], v[28:31], a[32:35]
    v_exp_f32 v104, v104
    v_mfma_f32_16x16x32_bf16 a[36:39], v[228:231], v[36:39], a[36:39]
    s_waitcnt lgkmcnt(2)
    v_exp_f32 v105, v105
    v_mfma_f32_16x16x32_bf16 a[40:43], v[232:235], v[4:7], a[40:43]
    buffer_load_dwordx4 v198, s[16:19], s55 offen offset:2048 lds
    v_cvt_pk_bf16_f32 v101, v102, v103
    v_mfma_f32_16x16x32_bf16 a[44:47], v[232:235], v[12:15], a[44:47]
    ds_read_b64_tr_b16 v[244:245], v193 offset:32768
    ds_read_b64_tr_b16 v[246:247], v193 offset:36864
    v_mfma_f32_16x16x32_bf16 a[48:51], v[232:235], v[20:23], a[48:51]
    v_exp_f32 v106, v106
    v_mfma_f32_16x16x32_bf16 a[52:55], v[232:235], v[28:31], a[52:55]
    v_exp_f32 v107, v107
    v_mfma_f32_16x16x32_bf16 a[56:59], v[232:235], v[36:39], a[56:59]
    v_cvt_pk_bf16_f32 v102, v104, v105
    v_cvt_pk_bf16_f32 v103, v106, v107
    v_mfma_f32_16x16x32_bf16 a[60:63], v[236:239], v[4:7], a[60:63]
    buffer_load_dwordx4 v199, s[16:19], s55 offen offset:3072 lds
    v_mfma_f32_16x16x32_bf16 a[64:67], v[236:239], v[12:15], a[64:67]
    s_add_u32 m0, s30, 24576
    v_exp_f32 v108, v108
    v_mfma_f32_16x16x32_bf16 a[68:71], v[236:239], v[20:23], a[68:71]
    ds_read_b64_tr_b16 v[248:249], v194 offset:32768
    ds_read_b64_tr_b16 v[250:251], v194 offset:36864
    v_mfma_f32_16x16x32_bf16 a[72:75], v[236:239], v[28:31], a[72:75]
    v_exp_f32 v109, v109
    v_mfma_f32_16x16x32_bf16 a[76:79], v[236:239], v[36:39], a[76:79]
    s_waitcnt lgkmcnt(2)
    v_exp_f32 v110, v110
    v_mfma_f32_16x16x32_bf16 a[232:235], a[252:255], v[4:7], a[232:235]
    buffer_load_dwordx4 v200, s[20:23], s50 offen offset:0 lds
    v_cvt_pk_bf16_f32 v108, v108, v109
    v_mfma_f32_16x16x32_bf16 a[80:83], v[240:243], v[4:7], a[80:83]
    v_exp_f32 v111, v111
    v_mfma_f32_16x16x32_bf16 a[84:87], v[240:243], v[12:15], a[84:87]
    v_exp_f32 v112, v112
    v_mfma_f32_16x16x32_bf16 a[88:91], v[240:243], v[20:23], a[88:91]
    ds_read_b64_tr_b16 v[252:253], v195 offset:32768
    ds_read_b64_tr_b16 v[254:255], v195 offset:36864
    v_mfma_f32_16x16x32_bf16 a[92:95], v[240:243], v[28:31], a[92:95]
    v_exp_f32 v113, v113
    v_mfma_f32_16x16x32_bf16 a[96:99], v[240:243], v[36:39], a[96:99]
    buffer_load_dwordx4 v201, s[20:23], s50 offen offset:1024 lds
    v_cvt_pk_bf16_f32 v109, v110, v111
    v_mfma_f32_16x16x32_bf16 a[236:239], a[252:255], v[12:15], a[236:239]
    v_exp_f32 v114, v114
    v_mfma_f32_16x16x32_bf16 a[100:103], v[244:247], v[4:7], a[100:103]
    v_exp_f32 v115, v115
    v_mfma_f32_16x16x32_bf16 a[104:107], v[244:247], v[12:15], a[104:107]
    s_waitcnt vmcnt(22) lgkmcnt(2)
    v_cvt_pk_bf16_f32 v110, v112, v113
    v_cvt_pk_bf16_f32 v111, v114, v115
    v_mfma_f32_16x16x32_bf16 a[108:111], v[244:247], v[20:23], a[108:111]
    ds_read_b128 a[200:203], v184 offset:0
    ds_read_b128 a[204:207], v185 offset:0
    v_mfma_f32_16x16x32_bf16 a[112:115], v[244:247], v[28:31], a[112:115]
    buffer_load_dwordx4 v200, s[20:23], s50 offen offset:2048 lds
    ds_read_b128 a[208:211], v186 offset:0
    v_mfma_f32_16x16x32_bf16 a[116:119], v[244:247], v[36:39], a[116:119]
    v_exp_f32 v116, v116
    v_mfma_f32_16x16x32_bf16 a[240:243], a[252:255], v[20:23], a[240:243]
    v_exp_f32 v117, v117
    v_mfma_f32_16x16x32_bf16 v[144:147], v[248:251], v[4:7], v[144:147]
    ds_read_b128 a[212:215], v187 offset:0
    v_cvt_pk_bf16_f32 v116, v116, v117
    v_mfma_f32_16x16x32_bf16 v[148:151], v[248:251], v[12:15], v[148:151]
    v_exp_f32 v118, v118
    v_mfma_f32_16x16x32_bf16 v[152:155], v[248:251], v[20:23], v[152:155]
    buffer_load_dwordx4 v201, s[20:23], s50 offen offset:3072 lds
    v_mfma_f32_16x16x32_bf16 v[156:159], v[248:251], v[28:31], v[156:159]
    s_add_u32 m0, s30, 28672
    v_exp_f32 v119, v119
    v_mfma_f32_16x16x32_bf16 v[160:163], v[248:251], v[36:39], v[160:163]
    v_exp_f32 v120, v120
    v_mfma_f32_16x16x32_bf16 a[244:247], a[252:255], v[28:31], a[244:247]
    s_waitcnt lgkmcnt(1)
    v_exp_f32 v121, v121
    v_mfma_f32_16x16x32_bf16 v[164:167], v[252:255], v[4:7], v[164:167]
    v_exp_f32 v122, v122
    v_mfma_f32_16x16x32_bf16 v[168:171], v[252:255], v[12:15], v[168:171]
    buffer_load_dwordx4 v200, s[20:23], s51 offen offset:0 lds
    v_cvt_pk_bf16_f32 v117, v118, v119
    v_mfma_f32_16x16x32_bf16 v[172:175], v[252:255], v[20:23], v[172:175]
    v_exp_f32 v123, v123
    v_mfma_f32_16x16x32_bf16 v[176:179], v[252:255], v[28:31], v[176:179]
    v_cvt_pk_bf16_f32 v118, v120, v121
    v_cvt_pk_bf16_f32 v119, v122, v123
    v_mfma_f32_16x16x32_bf16 v[180:183], v[252:255], v[36:39], v[180:183]
    v_mfma_f32_16x16x32_bf16 a[248:251], a[252:255], v[36:39], a[248:251]
    v_mfma_f32_16x16x32_bf16 v[4:7], a[200:203], a[120:123], v[124:127]
    buffer_load_dwordx4 v201, s[20:23], s51 offen offset:1024 lds
    v_mfma_f32_16x16x32_bf16 v[4:7], a[204:207], a[124:127], v[4:7]
    v_mfma_f32_16x16x32_bf16 v[4:7], a[208:211], a[128:131], v[4:7]
    s_waitcnt lgkmcnt(0)
    v_mfma_f32_16x16x32_bf16 v[4:7], a[212:215], a[132:135], v[4:7]
    s_waitcnt vmcnt(22)
    v_mfma_f32_16x16x32_bf16 v[12:15], a[200:203], a[136:139], v[128:131]
    ds_read_b128 a[216:219], v184 offset:4096
    ds_read_b128 a[220:223], v185 offset:4096
    v_mfma_f32_16x16x32_bf16 v[12:15], a[204:207], a[140:143], v[12:15]
    buffer_load_dwordx4 v200, s[20:23], s51 offen offset:2048 lds
    ds_read_b128 a[224:227], v186 offset:4096
    v_mfma_f32_16x16x32_bf16 v[12:15], a[208:211], a[144:147], v[12:15]
    ds_read_b128 a[228:231], v187 offset:4096
    v_mfma_f32_16x16x32_bf16 v[12:15], a[212:215], a[148:151], v[12:15]
    v_exp_f32 v4, v4
    v_mfma_f32_16x16x32_bf16 v[20:23], a[200:203], a[152:155], v[132:135]
    v_exp_f32 v5, v5
    v_mfma_f32_16x16x32_bf16 v[20:23], a[204:207], a[156:159], v[20:23]
    v_exp_f32 v6, v6
    v_mfma_f32_16x16x32_bf16 v[20:23], a[208:211], a[160:163], v[20:23]
    buffer_load_dwordx4 v201, s[20:23], s51 offen offset:3072 lds
    v_cvt_pk_bf16_f32 v4, v4, v5
    v_mfma_f32_16x16x32_bf16 v[20:23], a[212:215], a[164:167], v[20:23]
    s_add_u32 m0, s30, 32768
    v_exp_f32 v7, v7
    v_mfma_f32_16x16x32_bf16 v[28:31], a[200:203], a[168:171], v[136:139]
    v_cvt_pk_bf16_f32 v5, v6, v7
    v_mfma_f32_16x16x32_bf16 v[28:31], a[204:207], a[172:175], v[28:31]
    v_exp_f32 v12, v12
    v_mfma_f32_16x16x32_bf16 v[28:31], a[208:211], a[176:179], v[28:31]
    v_exp_f32 v13, v13
    v_mfma_f32_16x16x32_bf16 v[28:31], a[212:215], a[180:183], v[28:31]
    buffer_load_dwordx4 v200, s[20:23], s52 offen offset:0 lds
    v_cvt_pk_bf16_f32 v12, v12, v13
    v_mfma_f32_16x16x32_bf16 v[36:39], a[200:203], a[184:187], v[140:143]
    v_exp_f32 v14, v14
    v_mfma_f32_16x16x32_bf16 v[36:39], a[204:207], a[188:191], v[36:39]
    v_exp_f32 v15, v15
    v_mfma_f32_16x16x32_bf16 v[36:39], a[208:211], a[192:195], v[36:39]
    v_cvt_pk_bf16_f32 v13, v14, v15
    v_mfma_f32_16x16x32_bf16 v[36:39], a[212:215], a[196:199], v[36:39]
    s_waitcnt lgkmcnt(0)
    v_exp_f32 v20, v20
    v_mfma_f32_16x16x32_bf16 v[8:11], a[216:219], a[120:123], v[124:127]
    buffer_load_dwordx4 v201, s[20:23], s52 offen offset:1024 lds
    v_mfma_f32_16x16x32_bf16 v[8:11], a[220:223], a[124:127], v[8:11]
    v_exp_f32 v21, v21
    v_mfma_f32_16x16x32_bf16 v[8:11], a[224:227], a[128:131], v[8:11]
    v_exp_f32 v22, v22
    v_mfma_f32_16x16x32_bf16 v[8:11], a[228:231], a[132:135], v[8:11]
    s_waitcnt vmcnt(18)
    v_exp_f32 v23, v23
    v_mfma_f32_16x16x32_bf16 v[16:19], a[216:219], a[136:139], v[128:131]
    ds_read_b64_tr_b16 v[224:225], v188 offset:8192
    ds_read_b64_tr_b16 v[226:227], v188 offset:12288
    v_mfma_f32_16x16x32_bf16 v[16:19], a[220:223], a[140:143], v[16:19]
    buffer_load_dwordx4 v200, s[20:23], s52 offen offset:2048 lds
    v_cvt_pk_bf16_f32 v20, v20, v21
    v_mfma_f32_16x16x32_bf16 v[16:19], a[224:227], a[144:147], v[16:19]
    v_exp_f32 v8, v8
    v_mfma_f32_16x16x32_bf16 v[16:19], a[228:231], a[148:151], v[16:19]
    v_exp_f32 v9, v9
    v_mfma_f32_16x16x32_bf16 v[24:27], a[216:219], a[152:155], v[132:135]
    v_exp_f32 v10, v10
    v_mfma_f32_16x16x32_bf16 v[24:27], a[220:223], a[156:159], v[24:27]
    ds_read_b64_tr_b16 v[228:229], v189 offset:8192
    ds_read_b64_tr_b16 v[230:231], v189 offset:12288
    v_mfma_f32_16x16x32_bf16 v[24:27], a[224:227], a[160:163], v[24:27]
    buffer_load_dwordx4 v201, s[20:23], s52 offen offset:3072 lds
    v_cvt_pk_bf16_f32 v6, v8, v9
    v_mfma_f32_16x16x32_bf16 v[24:27], a[228:231], a[164:167], v[24:27]
    s_add_u32 m0, s30, 36864
    v_exp_f32 v11, v11
    v_mfma_f32_16x16x32_bf16 v[32:35], a[216:219], a[168:171], v[136:139]
    v_cvt_pk_bf16_f32 v7, v10, v11
    v_cvt_pk_bf16_f32 v21, v22, v23
    v_mfma_f32_16x16x32_bf16 v[32:35], a[220:223], a[172:175], v[32:35]
    v_exp_f32 v16, v16
    v_mfma_f32_16x16x32_bf16 v[32:35], a[224:227], a[176:179], v[32:35]
    ds_read_b64_tr_b16 v[232:233], v190 offset:8192
    ds_read_b64_tr_b16 v[234:235], v190 offset:12288
    v_mfma_f32_16x16x32_bf16 v[32:35], a[228:231], a[180:183], v[32:35]
    buffer_load_dwordx4 v200, s[20:23], s53 offen offset:0 lds
    v_mfma_f32_16x16x32_bf16 v[40:43], a[216:219], a[184:187], v[140:143]
    v_exp_f32 v17, v17
    v_mfma_f32_16x16x32_bf16 v[40:43], a[220:223], a[188:191], v[40:43]
    v_exp_f32 v18, v18
    v_mfma_f32_16x16x32_bf16 v[40:43], a[224:227], a[192:195], v[40:43]
    s_waitcnt lgkmcnt(2)
    v_exp_f32 v19, v19
    v_mfma_f32_16x16x32_bf16 v[40:43], a[228:231], a[196:199], v[40:43]
    ds_read_b64_tr_b16 v[236:237], v191 offset:8192
    ds_read_b64_tr_b16 v[238:239], v191 offset:12288
    v_mfma_f32_16x16x32_bf16 a[0:3], v[224:227], v[44:47], a[0:3]
    buffer_load_dwordx4 v201, s[20:23], s53 offen offset:1024 lds
    v_cvt_pk_bf16_f32 v14, v16, v17
    v_mfma_f32_16x16x32_bf16 a[4:7], v[224:227], v[52:55], a[4:7]
    v_cvt_pk_bf16_f32 v15, v18, v19
    v_mfma_f32_16x16x32_bf16 a[8:11], v[224:227], v[60:63], a[8:11]
    v_exp_f32 v24, v24
    v_mfma_f32_16x16x32_bf16 a[12:15], v[224:227], v[68:71], a[12:15]
    v_exp_f32 v25, v25
    v_mfma_f32_16x16x32_bf16 a[16:19], v[224:227], v[76:79], a[16:19]
    v_exp_f32 v26, v26
    v_mfma_f32_16x16x32_bf16 a[20:23], v[228:231], v[44:47], a[20:23]
    buffer_load_dwordx4 v200, s[20:23], s53 offen offset:2048 lds
    ds_read_b64_tr_b16 v[240:241], v192 offset:8192
    v_mfma_f32_16x16x32_bf16 a[24:27], v[228:231], v[52:55], a[24:27]
    ds_read_b64_tr_b16 v[242:243], v192 offset:12288
    v_cvt_pk_bf16_f32 v22, v24, v25
    v_mfma_f32_16x16x32_bf16 a[28:31], v[228:231], v[60:63], a[28:31]
    v_exp_f32 v27, v27
    v_mfma_f32_16x16x32_bf16 a[32:35], v[228:231], v[68:71], a[32:35]
    v_cvt_pk_bf16_f32 v23, v26, v27
    v_mfma_f32_16x16x32_bf16 a[36:39], v[228:231], v[76:79], a[36:39]
    s_waitcnt lgkmcnt(2)
    v_exp_f32 v28, v28
    v_mfma_f32_16x16x32_bf16 a[40:43], v[232:235], v[44:47], a[40:43]
    buffer_load_dwordx4 v201, s[20:23], s53 offen offset:3072 lds
    v_mfma_f32_16x16x32_bf16 a[44:47], v[232:235], v[52:55], a[44:47]
    s_add_u32 m0, s30, 0
    v_exp_f32 v29, v29
    v_mfma_f32_16x16x32_bf16 a[48:51], v[232:235], v[60:63], a[48:51]
    ds_read_b64_tr_b16 v[244:245], v193 offset:8192
    ds_read_b64_tr_b16 v[246:247], v193 offset:12288
    v_mfma_f32_16x16x32_bf16 a[52:55], v[232:235], v[68:71], a[52:55]
    v_exp_f32 v30, v30
    v_mfma_f32_16x16x32_bf16 a[56:59], v[232:235], v[76:79], a[56:59]
    v_exp_f32 v31, v31
    v_mfma_f32_16x16x32_bf16 a[60:63], v[236:239], v[44:47], a[60:63]
    buffer_load_dwordx4 v200, s[20:23], s54 offen offset:0 lds
    v_cvt_pk_bf16_f32 v28, v28, v29
    v_mfma_f32_16x16x32_bf16 a[64:67], v[236:239], v[52:55], a[64:67]
    v_exp_f32 v32, v32
    v_mfma_f32_16x16x32_bf16 a[68:71], v[236:239], v[60:63], a[68:71]
    ds_read_b64_tr_b16 v[248:249], v194 offset:8192
    ds_read_b64_tr_b16 v[250:251], v194 offset:12288
    v_mfma_f32_16x16x32_bf16 a[72:75], v[236:239], v[68:71], a[72:75]
    v_exp_f32 v33, v33
    v_mfma_f32_16x16x32_bf16 a[76:79], v[236:239], v[76:79], a[76:79]
    s_waitcnt lgkmcnt(2)
    v_exp_f32 v34, v34
    v_mfma_f32_16x16x32_bf16 a[232:235], a[252:255], v[44:47], a[232:235]
    buffer_load_dwordx4 v201, s[20:23], s54 offen offset:1024 lds
    v_cvt_pk_bf16_f32 v29, v30, v31
    v_mfma_f32_16x16x32_bf16 a[80:83], v[240:243], v[44:47], a[80:83]
    v_exp_f32 v35, v35
    v_mfma_f32_16x16x32_bf16 a[84:87], v[240:243], v[52:55], a[84:87]
    v_cvt_pk_bf16_f32 v30, v32, v33
    v_cvt_pk_bf16_f32 v31, v34, v35
    v_mfma_f32_16x16x32_bf16 a[88:91], v[240:243], v[60:63], a[88:91]
    ds_read_b64_tr_b16 v[252:253], v195 offset:8192
    ds_read_b64_tr_b16 v[254:255], v195 offset:12288
    v_mfma_f32_16x16x32_bf16 a[92:95], v[240:243], v[68:71], a[92:95]
    v_exp_f32 v36, v36
    v_mfma_f32_16x16x32_bf16 a[96:99], v[240:243], v[76:79], a[96:99]
    buffer_load_dwordx4 v200, s[20:23], s54 offen offset:2048 lds
    v_mfma_f32_16x16x32_bf16 a[236:239], a[252:255], v[52:55], a[236:239]
    v_exp_f32 v37, v37
    v_mfma_f32_16x16x32_bf16 a[100:103], v[244:247], v[44:47], a[100:103]
    v_exp_f32 v38, v38
    v_mfma_f32_16x16x32_bf16 a[104:107], v[244:247], v[52:55], a[104:107]
    s_waitcnt vmcnt(23) lgkmcnt(2)
    v_exp_f32 v39, v39
    v_mfma_f32_16x16x32_bf16 a[108:111], v[244:247], v[60:63], a[108:111]
    ds_read_b128 a[200:203], v184 offset:16384
    ds_read_b128 a[204:207], v185 offset:16384
    v_mfma_f32_16x16x32_bf16 a[112:115], v[244:247], v[68:71], a[112:115]
    buffer_load_dwordx4 v201, s[20:23], s54 offen offset:3072 lds
    ds_read_b128 a[208:211], v186 offset:16384
    v_mfma_f32_16x16x32_bf16 a[116:119], v[244:247], v[76:79], a[116:119]
    s_add_u32 m0, s30, 4096
    v_exp_f32 v40, v40
    v_mfma_f32_16x16x32_bf16 a[240:243], a[252:255], v[60:63], a[240:243]
    ds_read_b128 a[212:215], v187 offset:16384
    v_cvt_pk_bf16_f32 v36, v36, v37
    v_mfma_f32_16x16x32_bf16 v[144:147], v[248:251], v[44:47], v[144:147]
    s_waitcnt vmcnt(20) lgkmcnt(4)
    ds_read_b128 a[216:219], v184 offset:20480
    ds_read_b128 a[220:223], v185 offset:20480
    v_mfma_f32_16x16x32_bf16 v[148:151], v[248:251], v[52:55], v[148:151]
    ds_read_b128 a[224:227], v186 offset:20480
    ds_read_b128 a[228:231], v187 offset:20480
    v_mfma_f32_16x16x32_bf16 v[152:155], v[248:251], v[60:63], v[152:155]
    buffer_load_dwordx4 v200, s[20:23], s55 offen offset:0 lds
    v_cvt_pk_bf16_f32 v37, v38, v39
    v_mfma_f32_16x16x32_bf16 v[156:159], v[248:251], v[68:71], v[156:159]
    v_exp_f32 v41, v41
    v_mfma_f32_16x16x32_bf16 v[160:163], v[248:251], v[76:79], v[160:163]
    v_exp_f32 v42, v42
    v_mfma_f32_16x16x32_bf16 a[244:247], a[252:255], v[68:71], a[244:247]
    v_exp_f32 v43, v43
    v_mfma_f32_16x16x32_bf16 v[164:167], v[252:255], v[44:47], v[164:167]
    v_cvt_pk_bf16_f32 v38, v40, v41
    v_cvt_pk_bf16_f32 v39, v42, v43
    v_mfma_f32_16x16x32_bf16 v[168:171], v[252:255], v[52:55], v[168:171]
    buffer_load_dwordx4 v201, s[20:23], s55 offen offset:1024 lds
    v_mfma_f32_16x16x32_bf16 v[172:175], v[252:255], v[60:63], v[172:175]
    v_mfma_f32_16x16x32_bf16 v[176:179], v[252:255], v[68:71], v[176:179]
    v_mfma_f32_16x16x32_bf16 v[180:183], v[252:255], v[76:79], v[180:183]
    v_mfma_f32_16x16x32_bf16 a[248:251], a[252:255], v[76:79], a[248:251]
    s_waitcnt lgkmcnt(0)
    v_mfma_f32_16x16x32_bf16 v[44:47], a[200:203], a[120:123], v[124:127]
    buffer_load_dwordx4 v200, s[20:23], s55 offen offset:2048 lds
    v_mfma_f32_16x16x32_bf16 v[44:47], a[204:207], a[124:127], v[44:47]
    v_mfma_f32_16x16x32_bf16 v[44:47], a[208:211], a[128:131], v[44:47]
    v_mfma_f32_16x16x32_bf16 v[44:47], a[212:215], a[132:135], v[44:47]
    s_waitcnt vmcnt(7)
    v_mfma_f32_16x16x32_bf16 v[48:51], a[216:219], a[120:123], v[124:127]
    ds_read_b64_tr_b16 v[224:225], v188 offset:24576
    ds_read_b64_tr_b16 v[226:227], v188 offset:28672
    v_mfma_f32_16x16x32_bf16 v[48:51], a[220:223], a[124:127], v[48:51]
    buffer_load_dwordx4 v201, s[20:23], s55 offen offset:3072 lds
    ds_read_b64_tr_b16 v[228:229], v188 offset:32768
    v_mfma_f32_16x16x32_bf16 v[48:51], a[224:227], a[128:131], v[48:51]
    ds_read_b64_tr_b16 v[230:231], v188 offset:36864
    ds_read_b64_tr_b16 v[236:237], v189 offset:24576
    v_mfma_f32_16x16x32_bf16 v[48:51], a[228:231], a[132:135], v[48:51]
    ds_read_b64_tr_b16 v[238:239], v189 offset:28672
    ds_read_b64_tr_b16 v[240:241], v189 offset:32768
    v_mfma_f32_16x16x32_bf16 v[52:55], a[200:203], a[136:139], v[128:131]
    ds_read_b64_tr_b16 v[242:243], v189 offset:36864
    ds_read_b64_tr_b16 v[248:249], v190 offset:24576
    v_mfma_f32_16x16x32_bf16 v[52:55], a[204:207], a[140:143], v[52:55]
    v_exp_f32 v44, v44
    v_mfma_f32_16x16x32_bf16 v[52:55], a[208:211], a[144:147], v[52:55]
    v_exp_f32 v45, v45
    v_mfma_f32_16x16x32_bf16 v[52:55], a[212:215], a[148:151], v[52:55]
    v_exp_f32 v46, v46
    v_mfma_f32_16x16x32_bf16 v[56:59], a[216:219], a[136:139], v[128:131]
    v_exp_f32 v47, v47
    v_mfma_f32_16x16x32_bf16 v[56:59], a[220:223], a[140:143], v[56:59]
    v_exp_f32 v48, v48
    v_mfma_f32_16x16x32_bf16 v[56:59], a[224:227], a[144:147], v[56:59]
    v_exp_f32 v49, v49
    v_mfma_f32_16x16x32_bf16 v[56:59], a[228:231], a[148:151], v[56:59]
    v_exp_f32 v50, v50
    v_mfma_f32_16x16x32_bf16 v[60:63], a[200:203], a[152:155], v[132:135]
    v_exp_f32 v51, v51
    v_mfma_f32_16x16x32_bf16 v[60:63], a[204:207], a[156:159], v[60:63]
    ds_read_b64_tr_b16 v[250:251], v190 offset:28672
    v_cvt_pk_bf16_f32 v44, v44, v45
    v_mfma_f32_16x16x32_bf16 v[60:63], a[208:211], a[160:163], v[60:63]
    ds_read_b64_tr_b16 v[252:253], v190 offset:32768
    v_cvt_pk_bf16_f32 v45, v46, v47
    v_mfma_f32_16x16x32_bf16 v[60:63], a[212:215], a[164:167], v[60:63]
    ds_read_b64_tr_b16 v[254:255], v190 offset:36864
    v_cvt_pk_bf16_f32 v46, v48, v49
    v_mfma_f32_16x16x32_bf16 v[64:67], a[216:219], a[152:155], v[132:135]
    ds_read_b64_tr_b16 a[124:125], v191 offset:24576
    v_cvt_pk_bf16_f32 v47, v50, v51
    v_mfma_f32_16x16x32_bf16 v[64:67], a[220:223], a[156:159], v[64:67]
    ds_read_b64_tr_b16 a[126:127], v191 offset:28672
    ds_read_b64_tr_b16 a[128:129], v191 offset:32768
    v_mfma_f32_16x16x32_bf16 v[64:67], a[224:227], a[160:163], v[64:67]
    ds_read_b64_tr_b16 a[130:131], v191 offset:36864
    ds_read_b64_tr_b16 a[136:137], v192 offset:24576
    v_mfma_f32_16x16x32_bf16 v[64:67], a[228:231], a[164:167], v[64:67]
    ds_read_b64_tr_b16 a[138:139], v192 offset:28672
    ds_read_b64_tr_b16 a[140:141], v192 offset:32768
    v_mfma_f32_16x16x32_bf16 v[68:71], a[200:203], a[168:171], v[136:139]
    ds_read_b64_tr_b16 a[142:143], v192 offset:36864
    ds_read_b64_tr_b16 a[148:149], v193 offset:24576
    v_mfma_f32_16x16x32_bf16 v[68:71], a[204:207], a[172:175], v[68:71]
    ds_read_b64_tr_b16 a[150:151], v193 offset:28672
    ds_read_b64_tr_b16 a[152:153], v193 offset:32768
    v_mfma_f32_16x16x32_bf16 v[68:71], a[208:211], a[176:179], v[68:71]
    ds_read_b64_tr_b16 a[154:155], v193 offset:36864
    ds_read_b64_tr_b16 a[160:161], v194 offset:24576
    v_mfma_f32_16x16x32_bf16 v[68:71], a[212:215], a[180:183], v[68:71]
    ds_read_b64_tr_b16 a[162:163], v194 offset:28672
    ds_read_b64_tr_b16 a[164:165], v194 offset:32768
    v_mfma_f32_16x16x32_bf16 v[72:75], a[216:219], a[168:171], v[136:139]
    v_exp_f32 v52, v52
    v_mfma_f32_16x16x32_bf16 v[72:75], a[220:223], a[172:175], v[72:75]
    ds_read_b64_tr_b16 a[166:167], v194 offset:36864
    ds_read_b64_tr_b16 a[172:173], v195 offset:24576
    v_mfma_f32_16x16x32_bf16 v[72:75], a[224:227], a[176:179], v[72:75]
    ds_read_b64_tr_b16 a[174:175], v195 offset:28672
    ds_read_b64_tr_b16 a[176:177], v195 offset:32768
    v_mfma_f32_16x16x32_bf16 v[72:75], a[228:231], a[180:183], v[72:75]
    v_exp_f32 v53, v53
    v_mfma_f32_16x16x32_bf16 v[76:79], a[200:203], a[184:187], v[140:143]
    ds_read_b64_tr_b16 a[178:179], v195 offset:36864
    v_cvt_pk_bf16_f32 v52, v52, v53
    v_mfma_f32_16x16x32_bf16 v[76:79], a[204:207], a[188:191], v[76:79]
    v_exp_f32 v54, v54
    v_mfma_f32_16x16x32_bf16 v[76:79], a[208:211], a[192:195], v[76:79]
    v_exp_f32 v55, v55
    v_mfma_f32_16x16x32_bf16 v[76:79], a[212:215], a[196:199], v[76:79]
    v_exp_f32 v56, v56
    v_mfma_f32_16x16x32_bf16 v[80:83], a[216:219], a[184:187], v[140:143]
    s_waitcnt vmcnt(0) lgkmcnt(3)
    v_exp_f32 v57, v57
    v_mfma_f32_16x16x32_bf16 v[80:83], a[220:223], a[188:191], v[80:83]
    ds_read_b64_tr_b16 v[232:233], v188 offset:0
    ds_read_b64_tr_b16 v[234:235], v188 offset:4096
    v_mfma_f32_16x16x32_bf16 v[80:83], a[224:227], a[192:195], v[80:83]
    ds_read_b64_tr_b16 v[244:245], v189 offset:0
    ds_read_b64_tr_b16 v[246:247], v189 offset:4096
    v_mfma_f32_16x16x32_bf16 v[80:83], a[228:231], a[196:199], v[80:83]
    ds_read_b64_tr_b16 a[120:121], v190 offset:0
    ds_read_b64_tr_b16 a[122:123], v190 offset:4096
    v_mfma_f32_16x16x32_bf16 a[232:235], a[252:255], v[84:87], a[232:235]
    ds_read_b64_tr_b16 a[132:133], v191 offset:0
    ds_read_b64_tr_b16 a[134:135], v191 offset:4096
    v_mfma_f32_16x16x32_bf16 a[232:235], a[252:255], v[4:7], a[232:235]
    ds_read_b64_tr_b16 a[144:145], v192 offset:0
    ds_read_b64_tr_b16 a[146:147], v192 offset:4096
    v_mfma_f32_16x16x32_bf16 a[232:235], a[252:255], v[44:47], a[232:235]
    ds_read_b64_tr_b16 a[156:157], v193 offset:0
    ds_read_b64_tr_b16 a[158:159], v193 offset:4096
    v_mfma_f32_16x16x32_bf16 a[0:3], v[224:227], v[84:87], a[0:3]
    ds_read_b64_tr_b16 a[168:169], v194 offset:0
    ds_read_b64_tr_b16 a[170:171], v194 offset:4096
    v_mfma_f32_16x16x32_bf16 a[0:3], v[228:231], v[4:7], a[0:3]
    ds_read_b64_tr_b16 a[180:181], v195 offset:0
    ds_read_b64_tr_b16 a[182:183], v195 offset:4096
    ds_write_b32 v222, a232 offset:0
    s_waitcnt lgkmcnt(13)
    v_mfma_f32_16x16x32_bf16 a[0:3], v[232:235], v[44:47], a[0:3]
    v_exp_f32 v58, v58
    v_mfma_f32_16x16x32_bf16 a[20:23], v[236:239], v[84:87], a[20:23]
    v_exp_f32 v59, v59
    v_mfma_f32_16x16x32_bf16 a[20:23], v[240:243], v[4:7], a[20:23]
    v_cvt_pk_bf16_f32 v53, v54, v55
    v_cvt_pk_bf16_f32 v54, v56, v57
    v_mfma_f32_16x16x32_bf16 a[20:23], v[244:247], v[44:47], a[20:23]
    v_cvt_pk_bf16_f32 v55, v58, v59
    v_mfma_f32_16x16x32_bf16 a[40:43], v[248:251], v[84:87], a[40:43]
    ds_write_b128 v2, a[0:3] offset:9728
    v_mfma_f32_16x16x32_bf16 a[40:43], v[252:255], v[4:7], a[40:43]
    s_waitcnt lgkmcnt(2)
    v_exp_f32 v60, v60
    v_mfma_f32_16x16x32_bf16 a[40:43], a[120:123], v[44:47], a[40:43]
    v_exp_f32 v61, v61
    v_mfma_f32_16x16x32_bf16 a[60:63], a[124:127], v[84:87], a[60:63]
    ds_write_b128 v2, a[20:23] offset:10752
    v_mfma_f32_16x16x32_bf16 a[60:63], a[128:131], v[4:7], a[60:63]
    v_exp_f32 v62, v62
    v_mfma_f32_16x16x32_bf16 a[60:63], a[132:135], v[44:47], a[60:63]
    v_exp_f32 v63, v63
    v_mfma_f32_16x16x32_bf16 a[80:83], a[136:139], v[84:87], a[80:83]
    ds_write_b128 v2, a[40:43] offset:11776
    v_mfma_f32_16x16x32_bf16 a[80:83], a[140:143], v[4:7], a[80:83]
    v_exp_f32 v64, v64
    v_mfma_f32_16x16x32_bf16 a[80:83], a[144:147], v[44:47], a[80:83]
    v_exp_f32 v65, v65
    v_mfma_f32_16x16x32_bf16 a[100:103], a[148:151], v[84:87], a[100:103]
    ds_write_b128 v2, a[60:63] offset:12800
    v_mfma_f32_16x16x32_bf16 a[100:103], a[152:155], v[4:7], a[100:103]
    v_exp_f32 v66, v66
    v_mfma_f32_16x16x32_bf16 a[100:103], a[156:159], v[44:47], a[100:103]
    v_exp_f32 v67, v67
    v_mfma_f32_16x16x32_bf16 v[144:147], a[160:163], v[84:87], v[144:147]
    ds_write_b128 v2, a[80:83] offset:13824
    v_mfma_f32_16x16x32_bf16 v[144:147], a[164:167], v[4:7], v[144:147]
    v_cvt_pk_bf16_f32 v60, v60, v61
    v_cvt_pk_bf16_f32 v61, v62, v63
    v_mfma_f32_16x16x32_bf16 v[144:147], a[168:171], v[44:47], v[144:147]
    v_cvt_pk_bf16_f32 v62, v64, v65
    v_cvt_pk_bf16_f32 v63, v66, v67
    v_mfma_f32_16x16x32_bf16 v[164:167], a[172:175], v[84:87], v[164:167]
    ds_write_b128 v2, a[100:103] offset:14848
    v_mfma_f32_16x16x32_bf16 v[164:167], a[176:179], v[4:7], v[164:167]
    v_exp_f32 v68, v68
    v_mfma_f32_16x16x32_bf16 v[164:167], a[180:183], v[44:47], v[164:167]
    v_exp_f32 v69, v69
    v_mfma_f32_16x16x32_bf16 a[236:239], a[252:255], v[92:95], a[236:239]
    v_exp_f32 v70, v70
    v_mfma_f32_16x16x32_bf16 a[236:239], a[252:255], v[12:15], a[236:239]
    v_exp_f32 v71, v71
    v_mfma_f32_16x16x32_bf16 a[236:239], a[252:255], v[52:55], a[236:239]
    s_waitcnt lgkmcnt(0)
    s_barrier
    v_exp_f32 v72, v72
    v_mfma_f32_16x16x32_bf16 a[4:7], v[224:227], v[92:95], a[4:7]
    ds_read2st64_b32 v[212:213], v219 offset0:0 offset1:160
    ds_read2st64_b32 v[210:211], v220 offset0:0 offset1:160
    v_mfma_f32_16x16x32_bf16 a[4:7], v[228:231], v[12:15], a[4:7]
    ds_read_b128 v[4:7], v216 offset:9728
    ds_read_b128 v[8:11], v216 offset:10752
    v_mfma_f32_16x16x32_bf16 a[4:7], v[232:235], v[52:55], a[4:7]
    ds_read_b128 v[44:47], v217 offset:11776
    ds_read_b128 v[48:51], v217 offset:12800
    v_mfma_f32_16x16x32_bf16 a[24:27], v[236:239], v[92:95], a[24:27]
    ds_read_b128 v[84:87], v218 offset:13824
    ds_read_b128 v[88:91], v218 offset:14848
    v_mfma_f32_16x16x32_bf16 a[24:27], v[240:243], v[12:15], a[24:27]
    ds_write_b32 v222, a236 offset:256
    v_cvt_pk_bf16_f32 v68, v68, v69
    v_mfma_f32_16x16x32_bf16 a[24:27], v[244:247], v[52:55], a[24:27]
    ds_write_b128 v2, a[4:7] offset:15872
    v_mfma_f32_16x16x32_bf16 a[44:47], v[248:251], v[92:95], a[44:47]
    v_exp_f32 v73, v73
    v_mfma_f32_16x16x32_bf16 a[44:47], v[252:255], v[12:15], a[44:47]
    s_waitcnt lgkmcnt(7)
    v_add_f32 v212, v212, v213
    v_add_f32 v210, v210, v211
    v_mfma_f32_16x16x32_bf16 a[44:47], a[120:123], v[52:55], a[44:47]
    v_add_f32 v212, v212, v210
    v_add_f32 v144, v144, v4
    v_mfma_f32_16x16x32_bf16 a[64:67], a[124:127], v[92:95], a[64:67]
    ds_write_b128 v2, a[24:27] offset:16896
    v_mfma_f32_16x16x32_bf16 a[64:67], a[128:131], v[12:15], a[64:67]
    v_rcp_f32 v204, v212
    v_mfma_f32_16x16x32_bf16 a[64:67], a[132:135], v[52:55], a[64:67]
    v_add_f32 v145, v145, v5
    v_add_f32 v146, v146, v6
    v_mfma_f32_16x16x32_bf16 a[84:87], a[136:139], v[92:95], a[84:87]
    ds_write_b128 v2, a[44:47] offset:17920
    v_mfma_f32_16x16x32_bf16 a[84:87], a[140:143], v[12:15], a[84:87]
    s_waitcnt lgkmcnt(4)
    v_add_f32 v147, v147, v7
    v_add_f32 v164, v164, v8
    v_mfma_f32_16x16x32_bf16 a[84:87], a[144:147], v[52:55], a[84:87]
    ds_write_b128 v2, a[64:67] offset:18944
    v_mfma_f32_16x16x32_bf16 a[104:107], a[148:151], v[92:95], a[104:107]
    v_add_f32 v165, v165, v9
    v_add_f32 v166, v166, v10
    v_mfma_f32_16x16x32_bf16 a[104:107], a[152:155], v[12:15], a[104:107]
    v_add_f32 v167, v167, v11
    v_add_f32 v144, v144, v44
    v_mfma_f32_16x16x32_bf16 a[104:107], a[156:159], v[52:55], a[104:107]
    ds_write_b128 v2, a[84:87] offset:19968
    v_mfma_f32_16x16x32_bf16 v[148:151], a[160:163], v[92:95], v[148:151]
    v_add_f32 v145, v145, v45
    v_add_f32 v146, v146, v46
    v_mfma_f32_16x16x32_bf16 v[148:151], a[164:167], v[12:15], v[148:151]
    v_add_f32 v147, v147, v47
    v_add_f32 v164, v164, v48
    v_mfma_f32_16x16x32_bf16 v[148:151], a[168:171], v[52:55], v[148:151]
    ds_write_b128 v2, a[104:107] offset:20992
    v_mfma_f32_16x16x32_bf16 v[168:171], a[172:175], v[92:95], v[168:171]
    v_add_f32 v165, v165, v49
    v_add_f32 v166, v166, v50
    v_mfma_f32_16x16x32_bf16 v[168:171], a[176:179], v[12:15], v[168:171]
    v_add_f32 v167, v167, v51
    v_add_f32 v144, v144, v84
    v_mfma_f32_16x16x32_bf16 v[168:171], a[180:183], v[52:55], v[168:171]
    v_add_f32 v145, v145, v85
    v_add_f32 v146, v146, v86
    v_mfma_f32_16x16x32_bf16 a[240:243], a[252:255], v[100:103], a[240:243]
    v_add_f32 v147, v147, v87
    v_add_f32 v164, v164, v88
    v_mfma_f32_16x16x32_bf16 a[240:243], a[252:255], v[20:23], a[240:243]
    s_waitcnt lgkmcnt(0)
    s_barrier
    v_add_f32 v165, v165, v89
    v_add_f32 v166, v166, v90
    v_mfma_f32_16x16x32_bf16 a[240:243], a[252:255], v[60:63], a[240:243]
    ds_read2st64_b32 v[210:211], v220 offset0:1 offset1:161
    ds_read_b128 v[12:15], v216 offset:15872
    v_mfma_f32_16x16x32_bf16 a[8:11], v[224:227], v[100:103], a[8:11]
    ds_read_b128 v[16:19], v216 offset:16896
    ds_read_b128 v[52:55], v217 offset:17920
    v_mfma_f32_16x16x32_bf16 a[8:11], v[228:231], v[20:23], a[8:11]
    ds_read_b128 v[56:59], v217 offset:18944
    ds_read_b128 v[92:95], v218 offset:19968
    v_mfma_f32_16x16x32_bf16 a[8:11], v[232:235], v[60:63], a[8:11]
    ds_read_b128 v[96:99], v218 offset:20992
    ds_write_b32 v222, a240 offset:512
    v_mfma_f32_16x16x32_bf16 a[28:31], v[236:239], v[100:103], a[28:31]
    v_add_f32 v167, v167, v91
    v_mul_f32 v144, v144, v204
    v_mfma_f32_16x16x32_bf16 a[28:31], v[240:243], v[20:23], a[28:31]
    v_mul_f32 v145, v145, v204
    v_cvt_pk_bf16_f32 v124, v144, v145
    v_mfma_f32_16x16x32_bf16 a[28:31], v[244:247], v[60:63], a[28:31]
    ds_write_b128 v2, a[8:11] offset:22016
    v_mfma_f32_16x16x32_bf16 a[48:51], v[248:251], v[100:103], a[48:51]
    v_mul_f32 v146, v146, v204
    v_mul_f32 v147, v147, v204
    v_mfma_f32_16x16x32_bf16 a[48:51], v[252:255], v[20:23], a[48:51]
    v_cvt_pk_bf16_f32 v125, v146, v147
    v_mul_f32 v164, v164, v204
    v_mfma_f32_16x16x32_bf16 a[48:51], a[120:123], v[60:63], a[48:51]
    ds_write_b128 v2, a[28:31] offset:23040
    v_mfma_f32_16x16x32_bf16 a[68:71], a[124:127], v[100:103], a[68:71]
    v_mul_f32 v165, v165, v204
    v_cvt_pk_bf16_f32 v126, v164, v165
    v_mfma_f32_16x16x32_bf16 a[68:71], a[128:131], v[20:23], a[68:71]
    v_mul_f32 v166, v166, v204
    v_mul_f32 v167, v167, v204
    v_mfma_f32_16x16x32_bf16 a[68:71], a[132:135], v[60:63], a[68:71]
    v_cvt_pk_bf16_f32 v127, v166, v167
    v_cmp_nge_f32 vcc, s67, v212
    v_mfma_f32_16x16x32_bf16 a[88:91], a[136:139], v[100:103], a[88:91]
    ds_write2_b64 v215, v[124:125], v[126:127] offset0:0 offset1:4
    v_mfma_f32_16x16x32_bf16 a[88:91], a[140:143], v[20:23], a[88:91]
    ds_write_b128 v2, a[48:51] offset:24064
    v_mfma_f32_16x16x32_bf16 a[88:91], a[144:147], v[60:63], a[88:91]
    ds_read2st64_b32 v[212:213], v219 offset0:1 offset1:161
    ds_read_b128 v[124:127], v214 offset:0
    v_mfma_f32_16x16x32_bf16 a[108:111], a[148:151], v[100:103], a[108:111]
    ds_write_b128 v2, a[68:71] offset:25088
    v_mfma_f32_16x16x32_bf16 a[108:111], a[152:155], v[20:23], a[108:111]
    s_or_b64 s[36:37], s[36:37], vcc
    s_waitcnt lgkmcnt(8)
    v_add_f32 v210, v210, v211
    v_add_f32 v148, v148, v12
    v_mfma_f32_16x16x32_bf16 a[108:111], a[156:159], v[60:63], a[108:111]
    ds_write_b128 v2, a[88:91] offset:26112
    v_mfma_f32_16x16x32_bf16 v[152:155], a[160:163], v[100:103], v[152:155]
    v_exp_f32 v74, v74
    v_mfma_f32_16x16x32_bf16 v[152:155], a[164:167], v[20:23], v[152:155]
    v_exp_f32 v75, v75
    v_mfma_f32_16x16x32_bf16 v[152:155], a[168:171], v[60:63], v[152:155]
    s_waitcnt lgkmcnt(2)
    v_add_f32 v212, v212, v213
    v_add_f32 v212, v212, v210
    v_mfma_f32_16x16x32_bf16 v[172:175], a[172:175], v[100:103], v[172:175]
    buffer_store_dwordx4 v[124:127], v223, s[24:27], s56 offen sc1
    v_mfma_f32_16x16x32_bf16 v[172:175], a[176:179], v[20:23], v[172:175]
    ds_write_b128 v2, a[108:111] offset:27136
    v_mfma_f32_16x16x32_bf16 v[172:175], a[180:183], v[60:63], v[172:175]
    v_rcp_f32 v205, v212
    v_mfma_f32_16x16x32_bf16 a[244:247], a[252:255], v[108:111], a[244:247]
    v_add_f32 v149, v149, v13
    v_add_f32 v150, v150, v14
    v_mfma_f32_16x16x32_bf16 a[244:247], a[252:255], v[28:31], a[244:247]
    s_waitcnt lgkmcnt(0)
    v_add_f32 v151, v151, v15
    v_add_f32 v168, v168, v16
    v_add_f32 v169, v169, v17
    v_add_f32 v170, v170, v18
    v_add_f32 v171, v171, v19
    s_barrier
    v_add_f32 v148, v148, v52
    v_add_f32 v149, v149, v53
    v_add_f32 v150, v150, v54
    v_add_f32 v151, v151, v55
    v_add_f32 v168, v168, v56
    v_add_f32 v169, v169, v57
    v_add_f32 v170, v170, v58
    v_add_f32 v171, v171, v59
    v_cvt_pk_bf16_f32 v69, v70, v71
    v_add_f32 v148, v148, v92
    v_add_f32 v149, v149, v93
    v_add_f32 v150, v150, v94
    v_add_f32 v151, v151, v95
    v_add_f32 v168, v168, v96
    v_add_f32 v169, v169, v97
    v_add_f32 v170, v170, v98
    v_add_f32 v171, v171, v99
    v_cvt_pk_bf16_f32 v70, v72, v73
    v_cvt_pk_bf16_f32 v71, v74, v75
    v_mul_f32 v148, v148, v205
    v_mul_f32 v149, v149, v205
    v_mfma_f32_16x16x32_bf16 a[244:247], a[252:255], v[68:71], a[244:247]
    ds_read2st64_b32 v[210:211], v220 offset0:2 offset1:162
    v_cvt_pk_bf16_f32 v128, v148, v149
    v_mfma_f32_16x16x32_bf16 a[12:15], v[224:227], v[108:111], a[12:15]
    ds_read_b128 v[20:23], v216 offset:22016
    ds_read_b128 v[24:27], v216 offset:23040
    v_mfma_f32_16x16x32_bf16 a[12:15], v[228:231], v[28:31], a[12:15]
    ds_read_b128 v[60:63], v217 offset:24064
    ds_read_b128 v[64:67], v217 offset:25088
    v_mfma_f32_16x16x32_bf16 a[12:15], v[232:235], v[68:71], a[12:15]
    ds_read_b128 v[100:103], v218 offset:26112
    ds_read_b128 v[104:107], v218 offset:27136
    v_mfma_f32_16x16x32_bf16 a[32:35], v[236:239], v[108:111], a[32:35]
    ds_write_b32 v222, a244 offset:768
    v_mul_f32 v150, v150, v205
    v_mfma_f32_16x16x32_bf16 a[32:35], v[240:243], v[28:31], a[32:35]
    v_mul_f32 v151, v151, v205
    v_cvt_pk_bf16_f32 v129, v150, v151
    v_mfma_f32_16x16x32_bf16 a[32:35], v[244:247], v[68:71], a[32:35]
    ds_write_b128 v2, a[12:15] offset:28160
    v_mfma_f32_16x16x32_bf16 a[52:55], v[248:251], v[108:111], a[52:55]
    v_mul_f32 v168, v168, v205
    v_mul_f32 v169, v169, v205
    v_mfma_f32_16x16x32_bf16 a[52:55], v[252:255], v[28:31], a[52:55]
    v_cvt_pk_bf16_f32 v130, v168, v169
    v_mul_f32 v170, v170, v205
    v_mfma_f32_16x16x32_bf16 a[52:55], a[120:123], v[68:71], a[52:55]
    ds_write_b128 v2, a[32:35] offset:29184
    v_mfma_f32_16x16x32_bf16 a[72:75], a[124:127], v[108:111], a[72:75]
    v_mul_f32 v171, v171, v205
    v_cvt_pk_bf16_f32 v131, v170, v171
    v_mfma_f32_16x16x32_bf16 a[72:75], a[128:131], v[28:31], a[72:75]
    ds_write2_b64 v215, v[128:129], v[130:131] offset0:160 offset1:164
    v_mfma_f32_16x16x32_bf16 a[72:75], a[132:135], v[68:71], a[72:75]
    s_waitcnt lgkmcnt(4)
    v_cmp_nge_f32 vcc, s67, v212
    v_add_f32 v210, v210, v211
    v_mfma_f32_16x16x32_bf16 a[92:95], a[136:139], v[108:111], a[92:95]
    ds_write_b128 v2, a[52:55] offset:30208
    v_mfma_f32_16x16x32_bf16 a[92:95], a[140:143], v[28:31], a[92:95]
    ds_read_b128 v[128:131], v214 offset:1280
    ds_read2st64_b32 v[212:213], v219 offset0:2 offset1:162
    v_mfma_f32_16x16x32_bf16 a[92:95], a[144:147], v[68:71], a[92:95]
    ds_write_b128 v2, a[72:75] offset:31232
    v_mfma_f32_16x16x32_bf16 a[112:115], a[148:151], v[108:111], a[112:115]
    s_or_b64 s[36:37], s[36:37], vcc
    v_exp_f32 v76, v76
    v_mfma_f32_16x16x32_bf16 a[112:115], a[152:155], v[28:31], a[112:115]
    v_exp_f32 v77, v77
    v_mfma_f32_16x16x32_bf16 a[112:115], a[156:159], v[68:71], a[112:115]
    s_waitcnt lgkmcnt(2)
    v_exp_f32 v78, v78
    v_mfma_f32_16x16x32_bf16 v[156:159], a[160:163], v[108:111], v[156:159]
    ds_write_b128 v2, a[92:95] offset:32256
    v_mfma_f32_16x16x32_bf16 v[156:159], a[164:167], v[28:31], v[156:159]
    buffer_store_dwordx4 v[128:131], v223, s[24:27], s57 offen sc1
    v_mfma_f32_16x16x32_bf16 v[156:159], a[168:171], v[68:71], v[156:159]
    s_waitcnt lgkmcnt(2)
    v_add_f32 v212, v212, v213
    v_add_f32 v212, v212, v210
    v_mfma_f32_16x16x32_bf16 v[176:179], a[172:175], v[108:111], v[176:179]
    ds_write_b128 v2, a[112:115] offset:33280
    v_mfma_f32_16x16x32_bf16 v[176:179], a[176:179], v[28:31], v[176:179]
    v_exp_f32 v79, v79
    v_mfma_f32_16x16x32_bf16 v[176:179], a[180:183], v[68:71], v[176:179]
    v_exp_f32 v80, v80
    v_mfma_f32_16x16x32_bf16 a[248:251], a[252:255], v[116:119], a[248:251]
    v_exp_f32 v81, v81
    v_mfma_f32_16x16x32_bf16 a[248:251], a[252:255], v[36:39], a[248:251]
    s_waitcnt lgkmcnt(0)
    v_exp_f32 v82, v82
    s_barrier
    v_exp_f32 v83, v83
    v_rcp_f32 v206, v212
    v_add_f32 v152, v152, v20
    v_add_f32 v153, v153, v21
    v_add_f32 v154, v154, v22
    v_add_f32 v155, v155, v23
    v_add_f32 v172, v172, v24
    v_add_f32 v173, v173, v25
    v_add_f32 v174, v174, v26
    v_add_f32 v175, v175, v27
    v_cvt_pk_bf16_f32 v76, v76, v77
    v_add_f32 v152, v152, v60
    v_add_f32 v153, v153, v61
    v_add_f32 v154, v154, v62
    v_add_f32 v155, v155, v63
    v_add_f32 v172, v172, v64
    v_add_f32 v173, v173, v65
    v_add_f32 v174, v174, v66
    v_add_f32 v175, v175, v67
    v_cvt_pk_bf16_f32 v77, v78, v79
    v_add_f32 v152, v152, v100
    v_add_f32 v153, v153, v101
    v_add_f32 v154, v154, v102
    v_add_f32 v155, v155, v103
    v_add_f32 v172, v172, v104
    v_add_f32 v173, v173, v105
    v_add_f32 v174, v174, v106
    v_add_f32 v175, v175, v107
    v_cvt_pk_bf16_f32 v78, v80, v81
    v_cvt_pk_bf16_f32 v79, v82, v83
    v_mul_f32 v152, v152, v206
    v_mul_f32 v153, v153, v206
    v_mfma_f32_16x16x32_bf16 a[248:251], a[252:255], v[76:79], a[248:251]
    ds_read2st64_b32 v[210:211], v220 offset0:3 offset1:163
    v_cvt_pk_bf16_f32 v132, v152, v153
    v_mfma_f32_16x16x32_bf16 a[16:19], v[224:227], v[116:119], a[16:19]
    ds_read_b128 v[28:31], v216 offset:28160
    ds_read_b128 v[32:35], v216 offset:29184
    v_mfma_f32_16x16x32_bf16 a[16:19], v[228:231], v[36:39], a[16:19]
    ds_read_b128 v[68:71], v217 offset:30208
    ds_read_b128 v[72:75], v217 offset:31232
    v_mfma_f32_16x16x32_bf16 a[16:19], v[232:235], v[76:79], a[16:19]
    ds_read_b128 v[108:111], v218 offset:32256
    ds_read_b128 v[112:115], v218 offset:33280
    v_mfma_f32_16x16x32_bf16 a[36:39], v[236:239], v[116:119], a[36:39]
    ds_write_b32 v222, a248 offset:1024
    v_mul_f32 v154, v154, v206
    v_mfma_f32_16x16x32_bf16 a[36:39], v[240:243], v[36:39], a[36:39]
    v_mul_f32 v155, v155, v206
    v_cvt_pk_bf16_f32 v133, v154, v155
    v_mfma_f32_16x16x32_bf16 a[36:39], v[244:247], v[76:79], a[36:39]
    ds_write_b128 v2, a[16:19] offset:34304
    v_mfma_f32_16x16x32_bf16 a[56:59], v[248:251], v[116:119], a[56:59]
    v_mul_f32 v172, v172, v206
    v_mul_f32 v173, v173, v206
    v_mfma_f32_16x16x32_bf16 a[56:59], v[252:255], v[36:39], a[56:59]
    v_cvt_pk_bf16_f32 v134, v172, v173
    v_mul_f32 v174, v174, v206
    v_mfma_f32_16x16x32_bf16 a[56:59], a[120:123], v[76:79], a[56:59]
    ds_write_b128 v2, a[36:39] offset:35328
    v_mfma_f32_16x16x32_bf16 a[76:79], a[124:127], v[116:119], a[76:79]
    v_mul_f32 v175, v175, v206
    v_cvt_pk_bf16_f32 v135, v174, v175
    v_mfma_f32_16x16x32_bf16 a[76:79], a[128:131], v[36:39], a[76:79]
    ds_write2_b64 v215, v[132:133], v[134:135] offset0:0 offset1:4
    v_mfma_f32_16x16x32_bf16 a[76:79], a[132:135], v[76:79], a[76:79]
    s_waitcnt lgkmcnt(4)
    v_cmp_nge_f32 vcc, s67, v212
    v_add_f32 v210, v210, v211
    v_mfma_f32_16x16x32_bf16 a[96:99], a[136:139], v[116:119], a[96:99]
    ds_write_b128 v2, a[56:59] offset:36352
    v_mfma_f32_16x16x32_bf16 a[96:99], a[140:143], v[36:39], a[96:99]
    ds_read_b128 v[132:135], v214 offset:0
    ds_read2st64_b32 v[212:213], v219 offset0:3 offset1:163
    v_mfma_f32_16x16x32_bf16 a[96:99], a[144:147], v[76:79], a[96:99]
    ds_write_b128 v2, a[76:79] offset:37376
    v_mfma_f32_16x16x32_bf16 a[116:119], a[148:151], v[116:119], a[116:119]
    s_or_b64 s[36:37], s[36:37], vcc
    v_mfma_f32_16x16x32_bf16 a[116:119], a[152:155], v[36:39], a[116:119]
    v_mfma_f32_16x16x32_bf16 a[116:119], a[156:159], v[76:79], a[116:119]
    v_mfma_f32_16x16x32_bf16 v[160:163], a[160:163], v[116:119], v[160:163]
    v_mfma_f32_16x16x32_bf16 v[160:163], a[164:167], v[36:39], v[160:163]
    s_waitcnt lgkmcnt(2)
    v_mfma_f32_16x16x32_bf16 v[160:163], a[168:171], v[76:79], v[160:163]
    buffer_store_dwordx4 v[132:135], v223, s[24:27], s58 offen sc1
    v_mfma_f32_16x16x32_bf16 v[180:183], a[172:175], v[116:119], v[180:183]
    ds_write_b128 v2, a[96:99] offset:38400
    v_mfma_f32_16x16x32_bf16 v[180:183], a[176:179], v[36:39], v[180:183]
    s_waitcnt lgkmcnt(2)
    v_add_f32 v212, v212, v213
    v_add_f32 v212, v212, v210
    v_mfma_f32_16x16x32_bf16 v[180:183], a[180:183], v[76:79], v[180:183]
    ds_write_b128 v2, a[116:119] offset:39424
    v_rcp_f32 v207, v212
    v_cmp_nge_f32 vcc, s67, v212
    v_pk_add_f32 v[156:157], v[156:157], v[28:29]
    v_pk_add_f32 v[158:159], v[158:159], v[30:31]
    v_pk_add_f32 v[176:177], v[176:177], v[32:33]
    v_pk_add_f32 v[178:179], v[178:179], v[34:35]
    v_pk_add_f32 v[156:157], v[156:157], v[68:69]
    v_pk_add_f32 v[158:159], v[158:159], v[70:71]
    v_pk_add_f32 v[176:177], v[176:177], v[72:73]
    v_pk_add_f32 v[178:179], v[178:179], v[74:75]
    v_pk_add_f32 v[156:157], v[156:157], v[108:109]
    v_pk_add_f32 v[158:159], v[158:159], v[110:111]
    v_pk_add_f32 v[176:177], v[176:177], v[112:113]
    v_pk_add_f32 v[178:179], v[178:179], v[114:115]
    v_pk_mul_f32 v[156:157], v[156:157], v[206:207] op_sel:[0,1] op_sel_hi:[1,1]
    v_pk_mul_f32 v[158:159], v[158:159], v[206:207] op_sel:[0,1] op_sel_hi:[1,1]
    v_pk_mul_f32 v[176:177], v[176:177], v[206:207] op_sel:[0,1] op_sel_hi:[1,1]
    v_pk_mul_f32 v[178:179], v[178:179], v[206:207] op_sel:[0,1] op_sel_hi:[1,1]
    v_cvt_pk_bf16_f32 v136, v156, v157
    v_cvt_pk_bf16_f32 v137, v158, v159
    v_cvt_pk_bf16_f32 v138, v176, v177
    v_cvt_pk_bf16_f32 v139, v178, v179
    ds_write2_b64 v215, v[136:137], v[138:139] offset0:160 offset1:164
    s_waitcnt lgkmcnt(1)
    s_barrier
    s_or_b64 s[36:37], s[36:37], vcc
    ds_read2st64_b32 v[212:213], v219 offset0:4 offset1:164
    ds_read2st64_b32 v[210:211], v220 offset0:4 offset1:164
    ds_read_b128 v[36:39], v216 offset:34304
    ds_read_b128 v[40:43], v216 offset:35328
    ds_read_b128 v[76:79], v217 offset:36352
    ds_read_b128 v[80:83], v217 offset:37376
    ds_read_b128 v[136:139], v214 offset:1280
    ds_read_b128 v[116:119], v218 offset:38400
    ds_read_b128 v[120:123], v218 offset:39424
    s_waitcnt lgkmcnt(8)
    v_add_f32 v212, v212, v213
    s_waitcnt lgkmcnt(3)
    v_add_f32 v210, v210, v211
    v_add_f32 v212, v212, v210
    v_rcp_f32 v208, v212
    v_cmp_nge_f32 vcc, s67, v212
    s_waitcnt lgkmcnt(0)
    buffer_store_dwordx4 v[136:139], v223, s[24:27], s59 offen sc1
    v_pk_add_f32 v[160:161], v[160:161], v[36:37]
    v_pk_add_f32 v[162:163], v[162:163], v[38:39]
    v_pk_add_f32 v[180:181], v[180:181], v[40:41]
    v_pk_add_f32 v[182:183], v[182:183], v[42:43]
    v_pk_add_f32 v[160:161], v[160:161], v[76:77]
    v_pk_add_f32 v[162:163], v[162:163], v[78:79]
    v_pk_add_f32 v[180:181], v[180:181], v[80:81]
    v_pk_add_f32 v[182:183], v[182:183], v[82:83]
    v_pk_add_f32 v[160:161], v[160:161], v[116:117]
    v_pk_add_f32 v[162:163], v[162:163], v[118:119]
    v_pk_add_f32 v[180:181], v[180:181], v[120:121]
    v_pk_add_f32 v[182:183], v[182:183], v[122:123]
    v_pk_mul_f32 v[160:161], v[160:161], v[208:209] op_sel:[0,0] op_sel_hi:[1,0]
    v_pk_mul_f32 v[162:163], v[162:163], v[208:209] op_sel:[0,0] op_sel_hi:[1,0]
    v_pk_mul_f32 v[180:181], v[180:181], v[208:209] op_sel:[0,0] op_sel_hi:[1,0]
    v_pk_mul_f32 v[182:183], v[182:183], v[208:209] op_sel:[0,0] op_sel_hi:[1,0]
    v_cvt_pk_bf16_f32 v140, v160, v161
    v_cvt_pk_bf16_f32 v141, v162, v163
    v_cvt_pk_bf16_f32 v142, v180, v181
    v_cvt_pk_bf16_f32 v143, v182, v183
    ds_write2_b64 v215, v[140:141], v[142:143] offset0:0 offset1:4
    s_or_b64 s[36:37], s[36:37], vcc
    s_nop 0
    ds_read_b128 v[140:143], v214 offset:0
    s_waitcnt lgkmcnt(0)
    buffer_store_dwordx4 v[140:143], v223, s[24:27], s60 offen sc1
    s_cmp_lg_u64 s[36:37], 0
    s_cselect_b32 s63, 1, 0
    s_cmp_gt_u32 s63, s32
    s_cbranch_scc1 L_slow
L_end:
    s_endpgm
L_slow:
    s_waitcnt vmcnt(0) lgkmcnt(0)
    s_nop 15
    s_barrier
    s_mov_b32 s32, 1
    v_mov_b32 v204, 0xff800000
    v_mov_b32 v205, 0xff800000
    v_mov_b32 v206, 0xff800000
    v_mov_b32 v207, 0xff800000
    v_mov_b32 v208, 0xff800000
    ds_write_b128 v3, v[204:207] offset:0
    ds_write_b32 v3, v208 offset:16
    s_waitcnt lgkmcnt(0)
    s_barrier
    v_and_b32 v212, 15, v1
    v_lshlrev_b32 v212, 8, v212
    v_lshrrev_b32 v213, 4, v1
    v_lshl_add_u32 v212, v213, 4, v212
    buffer_load_dwordx4 v[4:7], v212, s[12:15], s56 offen offset:0
    buffer_load_dwordx4 v[8:11], v212, s[12:15], s56 offen offset:64
    buffer_load_dwordx4 v[12:15], v212, s[12:15], s56 offen offset:128
    buffer_load_dwordx4 v[16:19], v212, s[12:15], s56 offen offset:192
    buffer_load_dwordx4 v[20:23], v212, s[12:15], s57 offen offset:0
    buffer_load_dwordx4 v[24:27], v212, s[12:15], s57 offen offset:64
    buffer_load_dwordx4 v[28:31], v212, s[12:15], s57 offen offset:128
    buffer_load_dwordx4 v[32:35], v212, s[12:15], s57 offen offset:192
    buffer_load_dwordx4 v[36:39], v212, s[12:15], s58 offen offset:0
    buffer_load_dwordx4 v[40:43], v212, s[12:15], s58 offen offset:64
    buffer_load_dwordx4 v[44:47], v212, s[12:15], s58 offen offset:128
    buffer_load_dwordx4 v[48:51], v212, s[12:15], s58 offen offset:192
    buffer_load_dwordx4 v[52:55], v212, s[12:15], s59 offen offset:0
    buffer_load_dwordx4 v[56:59], v212, s[12:15], s59 offen offset:64
    buffer_load_dwordx4 v[60:63], v212, s[12:15], s59 offen offset:128
    buffer_load_dwordx4 v[64:67], v212, s[12:15], s59 offen offset:192
    buffer_load_dwordx4 v[68:71], v212, s[12:15], s60 offen offset:0
    buffer_load_dwordx4 v[72:75], v212, s[12:15], s60 offen offset:64
    buffer_load_dwordx4 v[76:79], v212, s[12:15], s60 offen offset:128
    buffer_load_dwordx4 v[80:83], v212, s[12:15], s60 offen offset:192
    s_waitcnt vmcnt(19)
    v_lshlrev_b32 v124, 16, v4
    v_and_b32 v125, 0xffff0000, v4
    v_pk_mul_f32 v[124:125], v[124:125], s[34:35]
    v_cvt_pk_bf16_f32 v4, v124, v125
    v_accvgpr_write_b32 a120, v4
    v_lshlrev_b32 v124, 16, v5
    v_and_b32 v125, 0xffff0000, v5
    v_pk_mul_f32 v[124:125], v[124:125], s[34:35]
    v_cvt_pk_bf16_f32 v5, v124, v125
    v_accvgpr_write_b32 a121, v5
    v_lshlrev_b32 v124, 16, v6
    v_and_b32 v125, 0xffff0000, v6
    v_pk_mul_f32 v[124:125], v[124:125], s[34:35]
    v_cvt_pk_bf16_f32 v6, v124, v125
    v_accvgpr_write_b32 a122, v6
    v_lshlrev_b32 v124, 16, v7
    v_and_b32 v125, 0xffff0000, v7
    v_pk_mul_f32 v[124:125], v[124:125], s[34:35]
    v_cvt_pk_bf16_f32 v7, v124, v125
    v_accvgpr_write_b32 a123, v7
    s_waitcnt vmcnt(18)
    v_lshlrev_b32 v124, 16, v8
    v_and_b32 v125, 0xffff0000, v8
    v_pk_mul_f32 v[124:125], v[124:125], s[34:35]
    v_cvt_pk_bf16_f32 v8, v124, v125
    v_accvgpr_write_b32 a124, v8
    v_lshlrev_b32 v124, 16, v9
    v_and_b32 v125, 0xffff0000, v9
    v_pk_mul_f32 v[124:125], v[124:125], s[34:35]
    v_cvt_pk_bf16_f32 v9, v124, v125
    v_accvgpr_write_b32 a125, v9
    v_lshlrev_b32 v124, 16, v10
    v_and_b32 v125, 0xffff0000, v10
    v_pk_mul_f32 v[124:125], v[124:125], s[34:35]
    v_cvt_pk_bf16_f32 v10, v124, v125
    v_accvgpr_write_b32 a126, v10
    v_lshlrev_b32 v124, 16, v11
    v_and_b32 v125, 0xffff0000, v11
    v_pk_mul_f32 v[124:125], v[124:125], s[34:35]
    v_cvt_pk_bf16_f32 v11, v124, v125
    v_accvgpr_write_b32 a127, v11
    s_waitcnt vmcnt(17)
    v_lshlrev_b32 v124, 16, v12
    v_and_b32 v125, 0xffff0000, v12
    v_pk_mul_f32 v[124:125], v[124:125], s[34:35]
    v_cvt_pk_bf16_f32 v12, v124, v125
    v_accvgpr_write_b32 a128, v12
    v_lshlrev_b32 v124, 16, v13
    v_and_b32 v125, 0xffff0000, v13
    v_pk_mul_f32 v[124:125], v[124:125], s[34:35]
    v_cvt_pk_bf16_f32 v13, v124, v125
    v_accvgpr_write_b32 a129, v13
    v_lshlrev_b32 v124, 16, v14
    v_and_b32 v125, 0xffff0000, v14
    v_pk_mul_f32 v[124:125], v[124:125], s[34:35]
    v_cvt_pk_bf16_f32 v14, v124, v125
    v_accvgpr_write_b32 a130, v14
    v_lshlrev_b32 v124, 16, v15
    v_and_b32 v125, 0xffff0000, v15
    v_pk_mul_f32 v[124:125], v[124:125], s[34:35]
    v_cvt_pk_bf16_f32 v15, v124, v125
    v_accvgpr_write_b32 a131, v15
    s_waitcnt vmcnt(16)
    v_lshlrev_b32 v124, 16, v16
    v_and_b32 v125, 0xffff0000, v16
    v_pk_mul_f32 v[124:125], v[124:125], s[34:35]
    v_cvt_pk_bf16_f32 v16, v124, v125
    v_accvgpr_write_b32 a132, v16
    v_lshlrev_b32 v124, 16, v17
    v_and_b32 v125, 0xffff0000, v17
    v_pk_mul_f32 v[124:125], v[124:125], s[34:35]
    v_cvt_pk_bf16_f32 v17, v124, v125
    v_accvgpr_write_b32 a133, v17
    v_lshlrev_b32 v124, 16, v18
    v_and_b32 v125, 0xffff0000, v18
    v_pk_mul_f32 v[124:125], v[124:125], s[34:35]
    v_cvt_pk_bf16_f32 v18, v124, v125
    v_accvgpr_write_b32 a134, v18
    v_lshlrev_b32 v124, 16, v19
    v_and_b32 v125, 0xffff0000, v19
    v_pk_mul_f32 v[124:125], v[124:125], s[34:35]
    v_cvt_pk_bf16_f32 v19, v124, v125
    v_accvgpr_write_b32 a135, v19
    s_waitcnt vmcnt(15)
    v_lshlrev_b32 v124, 16, v20
    v_and_b32 v125, 0xffff0000, v20
    v_pk_mul_f32 v[124:125], v[124:125], s[34:35]
    v_cvt_pk_bf16_f32 v20, v124, v125
    v_accvgpr_write_b32 a136, v20
    v_lshlrev_b32 v124, 16, v21
    v_and_b32 v125, 0xffff0000, v21
    v_pk_mul_f32 v[124:125], v[124:125], s[34:35]
    v_cvt_pk_bf16_f32 v21, v124, v125
    v_accvgpr_write_b32 a137, v21
    v_lshlrev_b32 v124, 16, v22
    v_and_b32 v125, 0xffff0000, v22
    v_pk_mul_f32 v[124:125], v[124:125], s[34:35]
    v_cvt_pk_bf16_f32 v22, v124, v125
    v_accvgpr_write_b32 a138, v22
    v_lshlrev_b32 v124, 16, v23
    v_and_b32 v125, 0xffff0000, v23
    v_pk_mul_f32 v[124:125], v[124:125], s[34:35]
    v_cvt_pk_bf16_f32 v23, v124, v125
    v_accvgpr_write_b32 a139, v23
    s_waitcnt vmcnt(14)
    v_lshlrev_b32 v124, 16, v24
    v_and_b32 v125, 0xffff0000, v24
    v_pk_mul_f32 v[124:125], v[124:125], s[34:35]
    v_cvt_pk_bf16_f32 v24, v124, v125
    v_accvgpr_write_b32 a140, v24
    v_lshlrev_b32 v124, 16, v25
    v_and_b32 v125, 0xffff0000, v25
    v_pk_mul_f32 v[124:125], v[124:125], s[34:35]
    v_cvt_pk_bf16_f32 v25, v124, v125
    v_accvgpr_write_b32 a141, v25
    v_lshlrev_b32 v124, 16, v26
    v_and_b32 v125, 0xffff0000, v26
    v_pk_mul_f32 v[124:125], v[124:125], s[34:35]
    v_cvt_pk_bf16_f32 v26, v124, v125
    v_accvgpr_write_b32 a142, v26
    v_lshlrev_b32 v124, 16, v27
    v_and_b32 v125, 0xffff0000, v27
    v_pk_mul_f32 v[124:125], v[124:125], s[34:35]
    v_cvt_pk_bf16_f32 v27, v124, v125
    v_accvgpr_write_b32 a143, v27
    s_waitcnt vmcnt(13)
    v_lshlrev_b32 v124, 16, v28
    v_and_b32 v125, 0xffff0000, v28
    v_pk_mul_f32 v[124:125], v[124:125], s[34:35]
    v_cvt_pk_bf16_f32 v28, v124, v125
    v_accvgpr_write_b32 a144, v28
    v_lshlrev_b32 v124, 16, v29
    v_and_b32 v125, 0xffff0000, v29
    v_pk_mul_f32 v[124:125], v[124:125], s[34:35]
    v_cvt_pk_bf16_f32 v29, v124, v125
    v_accvgpr_write_b32 a145, v29
    v_lshlrev_b32 v124, 16, v30
    v_and_b32 v125, 0xffff0000, v30
    v_pk_mul_f32 v[124:125], v[124:125], s[34:35]
    v_cvt_pk_bf16_f32 v30, v124, v125
    v_accvgpr_write_b32 a146, v30
    v_lshlrev_b32 v124, 16, v31
    v_and_b32 v125, 0xffff0000, v31
    v_pk_mul_f32 v[124:125], v[124:125], s[34:35]
    v_cvt_pk_bf16_f32 v31, v124, v125
    v_accvgpr_write_b32 a147, v31
    s_waitcnt vmcnt(12)
    v_lshlrev_b32 v124, 16, v32
    v_and_b32 v125, 0xffff0000, v32
    v_pk_mul_f32 v[124:125], v[124:125], s[34:35]
    v_cvt_pk_bf16_f32 v32, v124, v125
    v_accvgpr_write_b32 a148, v32
    v_lshlrev_b32 v124, 16, v33
    v_and_b32 v125, 0xffff0000, v33
    v_pk_mul_f32 v[124:125], v[124:125], s[34:35]
    v_cvt_pk_bf16_f32 v33, v124, v125
    v_accvgpr_write_b32 a149, v33
    v_lshlrev_b32 v124, 16, v34
    v_and_b32 v125, 0xffff0000, v34
    v_pk_mul_f32 v[124:125], v[124:125], s[34:35]
    v_cvt_pk_bf16_f32 v34, v124, v125
    v_accvgpr_write_b32 a150, v34
    v_lshlrev_b32 v124, 16, v35
    v_and_b32 v125, 0xffff0000, v35
    v_pk_mul_f32 v[124:125], v[124:125], s[34:35]
    v_cvt_pk_bf16_f32 v35, v124, v125
    v_accvgpr_write_b32 a151, v35
    s_waitcnt vmcnt(11)
    v_lshlrev_b32 v124, 16, v36
    v_and_b32 v125, 0xffff0000, v36
    v_pk_mul_f32 v[124:125], v[124:125], s[34:35]
    v_cvt_pk_bf16_f32 v36, v124, v125
    v_accvgpr_write_b32 a152, v36
    v_lshlrev_b32 v124, 16, v37
    v_and_b32 v125, 0xffff0000, v37
    v_pk_mul_f32 v[124:125], v[124:125], s[34:35]
    v_cvt_pk_bf16_f32 v37, v124, v125
    v_accvgpr_write_b32 a153, v37
    v_lshlrev_b32 v124, 16, v38
    v_and_b32 v125, 0xffff0000, v38
    v_pk_mul_f32 v[124:125], v[124:125], s[34:35]
    v_cvt_pk_bf16_f32 v38, v124, v125
    v_accvgpr_write_b32 a154, v38
    v_lshlrev_b32 v124, 16, v39
    v_and_b32 v125, 0xffff0000, v39
    v_pk_mul_f32 v[124:125], v[124:125], s[34:35]
    v_cvt_pk_bf16_f32 v39, v124, v125
    v_accvgpr_write_b32 a155, v39
    s_waitcnt vmcnt(10)
    v_lshlrev_b32 v124, 16, v40
    v_and_b32 v125, 0xffff0000, v40
    v_pk_mul_f32 v[124:125], v[124:125], s[34:35]
    v_cvt_pk_bf16_f32 v40, v124, v125
    v_accvgpr_write_b32 a156, v40
    v_lshlrev_b32 v124, 16, v41
    v_and_b32 v125, 0xffff0000, v41
    v_pk_mul_f32 v[124:125], v[124:125], s[34:35]
    v_cvt_pk_bf16_f32 v41, v124, v125
    v_accvgpr_write_b32 a157, v41
    v_lshlrev_b32 v124, 16, v42
    v_and_b32 v125, 0xffff0000, v42
    v_pk_mul_f32 v[124:125], v[124:125], s[34:35]
    v_cvt_pk_bf16_f32 v42, v124, v125
    v_accvgpr_write_b32 a158, v42
    v_lshlrev_b32 v124, 16, v43
    v_and_b32 v125, 0xffff0000, v43
    v_pk_mul_f32 v[124:125], v[124:125], s[34:35]
    v_cvt_pk_bf16_f32 v43, v124, v125
    v_accvgpr_write_b32 a159, v43
    s_waitcnt vmcnt(9)
    v_lshlrev_b32 v124, 16, v44
    v_and_b32 v125, 0xffff0000, v44
    v_pk_mul_f32 v[124:125], v[124:125], s[34:35]
    v_cvt_pk_bf16_f32 v44, v124, v125
    v_accvgpr_write_b32 a160, v44
    v_lshlrev_b32 v124, 16, v45
    v_and_b32 v125, 0xffff0000, v45
    v_pk_mul_f32 v[124:125], v[124:125], s[34:35]
    v_cvt_pk_bf16_f32 v45, v124, v125
    v_accvgpr_write_b32 a161, v45
    v_lshlrev_b32 v124, 16, v46
    v_and_b32 v125, 0xffff0000, v46
    v_pk_mul_f32 v[124:125], v[124:125], s[34:35]
    v_cvt_pk_bf16_f32 v46, v124, v125
    v_accvgpr_write_b32 a162, v46
    v_lshlrev_b32 v124, 16, v47
    v_and_b32 v125, 0xffff0000, v47
    v_pk_mul_f32 v[124:125], v[124:125], s[34:35]
    v_cvt_pk_bf16_f32 v47, v124, v125
    v_accvgpr_write_b32 a163, v47
    s_waitcnt vmcnt(8)
    v_lshlrev_b32 v124, 16, v48
    v_and_b32 v125, 0xffff0000, v48
    v_pk_mul_f32 v[124:125], v[124:125], s[34:35]
    v_cvt_pk_bf16_f32 v48, v124, v125
    v_accvgpr_write_b32 a164, v48
    v_lshlrev_b32 v124, 16, v49
    v_and_b32 v125, 0xffff0000, v49
    v_pk_mul_f32 v[124:125], v[124:125], s[34:35]
    v_cvt_pk_bf16_f32 v49, v124, v125
    v_accvgpr_write_b32 a165, v49
    v_lshlrev_b32 v124, 16, v50
    v_and_b32 v125, 0xffff0000, v50
    v_pk_mul_f32 v[124:125], v[124:125], s[34:35]
    v_cvt_pk_bf16_f32 v50, v124, v125
    v_accvgpr_write_b32 a166, v50
    v_lshlrev_b32 v124, 16, v51
    v_and_b32 v125, 0xffff0000, v51
    v_pk_mul_f32 v[124:125], v[124:125], s[34:35]
    v_cvt_pk_bf16_f32 v51, v124, v125
    v_accvgpr_write_b32 a167, v51
    s_waitcnt vmcnt(7)
    v_lshlrev_b32 v124, 16, v52
    v_and_b32 v125, 0xffff0000, v52
    v_pk_mul_f32 v[124:125], v[124:125], s[34:35]
    v_cvt_pk_bf16_f32 v52, v124, v125
    v_accvgpr_write_b32 a168, v52
    v_lshlrev_b32 v124, 16, v53
    v_and_b32 v125, 0xffff0000, v53
    v_pk_mul_f32 v[124:125], v[124:125], s[34:35]
    v_cvt_pk_bf16_f32 v53, v124, v125
    v_accvgpr_write_b32 a169, v53
    v_lshlrev_b32 v124, 16, v54
    v_and_b32 v125, 0xffff0000, v54
    v_pk_mul_f32 v[124:125], v[124:125], s[34:35]
    v_cvt_pk_bf16_f32 v54, v124, v125
    v_accvgpr_write_b32 a170, v54
    v_lshlrev_b32 v124, 16, v55
    v_and_b32 v125, 0xffff0000, v55
    v_pk_mul_f32 v[124:125], v[124:125], s[34:35]
    v_cvt_pk_bf16_f32 v55, v124, v125
    v_accvgpr_write_b32 a171, v55
    s_waitcnt vmcnt(6)
    v_lshlrev_b32 v124, 16, v56
    v_and_b32 v125, 0xffff0000, v56
    v_pk_mul_f32 v[124:125], v[124:125], s[34:35]
    v_cvt_pk_bf16_f32 v56, v124, v125
    v_accvgpr_write_b32 a172, v56
    v_lshlrev_b32 v124, 16, v57
    v_and_b32 v125, 0xffff0000, v57
    v_pk_mul_f32 v[124:125], v[124:125], s[34:35]
    v_cvt_pk_bf16_f32 v57, v124, v125
    v_accvgpr_write_b32 a173, v57
    v_lshlrev_b32 v124, 16, v58
    v_and_b32 v125, 0xffff0000, v58
    v_pk_mul_f32 v[124:125], v[124:125], s[34:35]
    v_cvt_pk_bf16_f32 v58, v124, v125
    v_accvgpr_write_b32 a174, v58
    v_lshlrev_b32 v124, 16, v59
    v_and_b32 v125, 0xffff0000, v59
    v_pk_mul_f32 v[124:125], v[124:125], s[34:35]
    v_cvt_pk_bf16_f32 v59, v124, v125
    v_accvgpr_write_b32 a175, v59
    s_waitcnt vmcnt(5)
    v_lshlrev_b32 v124, 16, v60
    v_and_b32 v125, 0xffff0000, v60
    v_pk_mul_f32 v[124:125], v[124:125], s[34:35]
    v_cvt_pk_bf16_f32 v60, v124, v125
    v_accvgpr_write_b32 a176, v60
    v_lshlrev_b32 v124, 16, v61
    v_and_b32 v125, 0xffff0000, v61
    v_pk_mul_f32 v[124:125], v[124:125], s[34:35]
    v_cvt_pk_bf16_f32 v61, v124, v125
    v_accvgpr_write_b32 a177, v61
    v_lshlrev_b32 v124, 16, v62
    v_and_b32 v125, 0xffff0000, v62
    v_pk_mul_f32 v[124:125], v[124:125], s[34:35]
    v_cvt_pk_bf16_f32 v62, v124, v125
    v_accvgpr_write_b32 a178, v62
    v_lshlrev_b32 v124, 16, v63
    v_and_b32 v125, 0xffff0000, v63
    v_pk_mul_f32 v[124:125], v[124:125], s[34:35]
    v_cvt_pk_bf16_f32 v63, v124, v125
    v_accvgpr_write_b32 a179, v63
    s_waitcnt vmcnt(4)
    v_lshlrev_b32 v124, 16, v64
    v_and_b32 v125, 0xffff0000, v64
    v_pk_mul_f32 v[124:125], v[124:125], s[34:35]
    v_cvt_pk_bf16_f32 v64, v124, v125
    v_accvgpr_write_b32 a180, v64
    v_lshlrev_b32 v124, 16, v65
    v_and_b32 v125, 0xffff0000, v65
    v_pk_mul_f32 v[124:125], v[124:125], s[34:35]
    v_cvt_pk_bf16_f32 v65, v124, v125
    v_accvgpr_write_b32 a181, v65
    v_lshlrev_b32 v124, 16, v66
    v_and_b32 v125, 0xffff0000, v66
    v_pk_mul_f32 v[124:125], v[124:125], s[34:35]
    v_cvt_pk_bf16_f32 v66, v124, v125
    v_accvgpr_write_b32 a182, v66
    v_lshlrev_b32 v124, 16, v67
    v_and_b32 v125, 0xffff0000, v67
    v_pk_mul_f32 v[124:125], v[124:125], s[34:35]
    v_cvt_pk_bf16_f32 v67, v124, v125
    v_accvgpr_write_b32 a183, v67
    s_waitcnt vmcnt(3)
    v_lshlrev_b32 v124, 16, v68
    v_and_b32 v125, 0xffff0000, v68
    v_pk_mul_f32 v[124:125], v[124:125], s[34:35]
    v_cvt_pk_bf16_f32 v68, v124, v125
    v_accvgpr_write_b32 a184, v68
    v_lshlrev_b32 v124, 16, v69
    v_and_b32 v125, 0xffff0000, v69
    v_pk_mul_f32 v[124:125], v[124:125], s[34:35]
    v_cvt_pk_bf16_f32 v69, v124, v125
    v_accvgpr_write_b32 a185, v69
    v_lshlrev_b32 v124, 16, v70
    v_and_b32 v125, 0xffff0000, v70
    v_pk_mul_f32 v[124:125], v[124:125], s[34:35]
    v_cvt_pk_bf16_f32 v70, v124, v125
    v_accvgpr_write_b32 a186, v70
    v_lshlrev_b32 v124, 16, v71
    v_and_b32 v125, 0xffff0000, v71
    v_pk_mul_f32 v[124:125], v[124:125], s[34:35]
    v_cvt_pk_bf16_f32 v71, v124, v125
    v_accvgpr_write_b32 a187, v71
    s_waitcnt vmcnt(2)
    v_lshlrev_b32 v124, 16, v72
    v_and_b32 v125, 0xffff0000, v72
    v_pk_mul_f32 v[124:125], v[124:125], s[34:35]
    v_cvt_pk_bf16_f32 v72, v124, v125
    v_accvgpr_write_b32 a188, v72
    v_lshlrev_b32 v124, 16, v73
    v_and_b32 v125, 0xffff0000, v73
    v_pk_mul_f32 v[124:125], v[124:125], s[34:35]
    v_cvt_pk_bf16_f32 v73, v124, v125
    v_accvgpr_write_b32 a189, v73
    v_lshlrev_b32 v124, 16, v74
    v_and_b32 v125, 0xffff0000, v74
    v_pk_mul_f32 v[124:125], v[124:125], s[34:35]
    v_cvt_pk_bf16_f32 v74, v124, v125
    v_accvgpr_write_b32 a190, v74
    v_lshlrev_b32 v124, 16, v75
    v_and_b32 v125, 0xffff0000, v75
    v_pk_mul_f32 v[124:125], v[124:125], s[34:35]
    v_cvt_pk_bf16_f32 v75, v124, v125
    v_accvgpr_write_b32 a191, v75
    s_waitcnt vmcnt(1)
    v_lshlrev_b32 v124, 16, v76
    v_and_b32 v125, 0xffff0000, v76
    v_pk_mul_f32 v[124:125], v[124:125], s[34:35]
    v_cvt_pk_bf16_f32 v76, v124, v125
    v_accvgpr_write_b32 a192, v76
    v_lshlrev_b32 v124, 16, v77
    v_and_b32 v125, 0xffff0000, v77
    v_pk_mul_f32 v[124:125], v[124:125], s[34:35]
    v_cvt_pk_bf16_f32 v77, v124, v125
    v_accvgpr_write_b32 a193, v77
    v_lshlrev_b32 v124, 16, v78
    v_and_b32 v125, 0xffff0000, v78
    v_pk_mul_f32 v[124:125], v[124:125], s[34:35]
    v_cvt_pk_bf16_f32 v78, v124, v125
    v_accvgpr_write_b32 a194, v78
    v_lshlrev_b32 v124, 16, v79
    v_and_b32 v125, 0xffff0000, v79
    v_pk_mul_f32 v[124:125], v[124:125], s[34:35]
    v_cvt_pk_bf16_f32 v79, v124, v125
    v_accvgpr_write_b32 a195, v79
    s_waitcnt vmcnt(0)
    v_lshlrev_b32 v124, 16, v80
    v_and_b32 v125, 0xffff0000, v80
    v_pk_mul_f32 v[124:125], v[124:125], s[34:35]
    v_cvt_pk_bf16_f32 v80, v124, v125
    v_accvgpr_write_b32 a196, v80
    v_lshlrev_b32 v124, 16, v81
    v_and_b32 v125, 0xffff0000, v81
    v_pk_mul_f32 v[124:125], v[124:125], s[34:35]
    v_cvt_pk_bf16_f32 v81, v124, v125
    v_accvgpr_write_b32 a197, v81
    v_lshlrev_b32 v124, 16, v82
    v_and_b32 v125, 0xffff0000, v82
    v_pk_mul_f32 v[124:125], v[124:125], s[34:35]
    v_cvt_pk_bf16_f32 v82, v124, v125
    v_accvgpr_write_b32 a198, v82
    v_lshlrev_b32 v124, 16, v83
    v_and_b32 v125, 0xffff0000, v83
    v_pk_mul_f32 v[124:125], v[124:125], s[34:35]
    v_cvt_pk_bf16_f32 v83, v124, v125
    v_accvgpr_write_b32 a199, v83
    s_mov_b32 s64, 0
L_slow_loop:
    s_add_u32 m0, s30, 0
    s_add_u32 s65, s64, 0
    buffer_load_dwordx4 v196, s[16:19], s65 offen offset:0 lds
    buffer_load_dwordx4 v197, s[16:19], s65 offen offset:1024 lds
    buffer_load_dwordx4 v198, s[16:19], s65 offen offset:2048 lds
    buffer_load_dwordx4 v199, s[16:19], s65 offen offset:3072 lds
    s_add_u32 m0, s30, 4096
    s_add_u32 s65, s64, 4096
    buffer_load_dwordx4 v196, s[16:19], s65 offen offset:0 lds
    buffer_load_dwordx4 v197, s[16:19], s65 offen offset:1024 lds
    buffer_load_dwordx4 v198, s[16:19], s65 offen offset:2048 lds
    buffer_load_dwordx4 v199, s[16:19], s65 offen offset:3072 lds
    s_waitcnt vmcnt(0)
    ds_read_b128 a[200:203], v184 offset:0
    ds_read_b128 a[204:207], v185 offset:0
    ds_read_b128 a[208:211], v186 offset:0
    ds_read_b128 a[212:215], v187 offset:0
    ds_read_b128 a[216:219], v184 offset:4096
    ds_read_b128 a[220:223], v185 offset:4096
    ds_read_b128 a[224:227], v186 offset:4096
    ds_read_b128 a[228:231], v187 offset:4096
    s_waitcnt lgkmcnt(7)
    v_mfma_f32_16x16x32_bf16 v[4:7], a[200:203], a[120:123], 0
    s_waitcnt lgkmcnt(6)
    v_mfma_f32_16x16x32_bf16 v[4:7], a[204:207], a[124:127], v[4:7]
    s_waitcnt lgkmcnt(5)
    v_mfma_f32_16x16x32_bf16 v[4:7], a[208:211], a[128:131], v[4:7]
    s_waitcnt lgkmcnt(4)
    v_mfma_f32_16x16x32_bf16 v[4:7], a[212:215], a[132:135], v[4:7]
    v_mfma_f32_16x16x32_bf16 v[12:15], a[200:203], a[136:139], 0
    v_mfma_f32_16x16x32_bf16 v[12:15], a[204:207], a[140:143], v[12:15]
    v_mfma_f32_16x16x32_bf16 v[12:15], a[208:211], a[144:147], v[12:15]
    v_mfma_f32_16x16x32_bf16 v[12:15], a[212:215], a[148:151], v[12:15]
    v_mfma_f32_16x16x32_bf16 v[20:23], a[200:203], a[152:155], 0
    v_mfma_f32_16x16x32_bf16 v[20:23], a[204:207], a[156:159], v[20:23]
    v_mfma_f32_16x16x32_bf16 v[20:23], a[208:211], a[160:163], v[20:23]
    v_mfma_f32_16x16x32_bf16 v[20:23], a[212:215], a[164:167], v[20:23]
    v_mfma_f32_16x16x32_bf16 v[28:31], a[200:203], a[168:171], 0
    v_mfma_f32_16x16x32_bf16 v[28:31], a[204:207], a[172:175], v[28:31]
    v_mfma_f32_16x16x32_bf16 v[28:31], a[208:211], a[176:179], v[28:31]
    v_mfma_f32_16x16x32_bf16 v[28:31], a[212:215], a[180:183], v[28:31]
    v_mfma_f32_16x16x32_bf16 v[36:39], a[200:203], a[184:187], 0
    v_mfma_f32_16x16x32_bf16 v[36:39], a[204:207], a[188:191], v[36:39]
    v_mfma_f32_16x16x32_bf16 v[36:39], a[208:211], a[192:195], v[36:39]
    v_mfma_f32_16x16x32_bf16 v[36:39], a[212:215], a[196:199], v[36:39]
    s_waitcnt lgkmcnt(3)
    v_mfma_f32_16x16x32_bf16 v[8:11], a[216:219], a[120:123], 0
    s_waitcnt lgkmcnt(2)
    v_mfma_f32_16x16x32_bf16 v[8:11], a[220:223], a[124:127], v[8:11]
    s_waitcnt lgkmcnt(1)
    v_mfma_f32_16x16x32_bf16 v[8:11], a[224:227], a[128:131], v[8:11]
    s_waitcnt lgkmcnt(0)
    v_mfma_f32_16x16x32_bf16 v[8:11], a[228:231], a[132:135], v[8:11]
    v_mfma_f32_16x16x32_bf16 v[16:19], a[216:219], a[136:139], 0
    v_mfma_f32_16x16x32_bf16 v[16:19], a[220:223], a[140:143], v[16:19]
    v_mfma_f32_16x16x32_bf16 v[16:19], a[224:227], a[144:147], v[16:19]
    v_mfma_f32_16x16x32_bf16 v[16:19], a[228:231], a[148:151], v[16:19]
    v_mfma_f32_16x16x32_bf16 v[24:27], a[216:219], a[152:155], 0
    v_mfma_f32_16x16x32_bf16 v[24:27], a[220:223], a[156:159], v[24:27]
    v_mfma_f32_16x16x32_bf16 v[24:27], a[224:227], a[160:163], v[24:27]
    v_mfma_f32_16x16x32_bf16 v[24:27], a[228:231], a[164:167], v[24:27]
    v_mfma_f32_16x16x32_bf16 v[32:35], a[216:219], a[168:171], 0
    v_mfma_f32_16x16x32_bf16 v[32:35], a[220:223], a[172:175], v[32:35]
    v_mfma_f32_16x16x32_bf16 v[32:35], a[224:227], a[176:179], v[32:35]
    v_mfma_f32_16x16x32_bf16 v[32:35], a[228:231], a[180:183], v[32:35]
    v_mfma_f32_16x16x32_bf16 v[40:43], a[216:219], a[184:187], 0
    v_mfma_f32_16x16x32_bf16 v[40:43], a[220:223], a[188:191], v[40:43]
    v_mfma_f32_16x16x32_bf16 v[40:43], a[224:227], a[192:195], v[40:43]
    v_mfma_f32_16x16x32_bf16 v[40:43], a[228:231], a[196:199], v[40:43]
    v_max3_f32 v204, v4, v5, v204
    v_max3_f32 v204, v6, v7, v204
    v_max3_f32 v204, v8, v9, v204
    v_max3_f32 v204, v10, v11, v204
    v_max3_f32 v205, v12, v13, v205
    v_max3_f32 v205, v14, v15, v205
    v_max3_f32 v205, v16, v17, v205
    v_max3_f32 v205, v18, v19, v205
    v_max3_f32 v206, v20, v21, v206
    v_max3_f32 v206, v22, v23, v206
    v_max3_f32 v206, v24, v25, v206
    v_max3_f32 v206, v26, v27, v206
    v_max3_f32 v207, v28, v29, v207
    v_max3_f32 v207, v30, v31, v207
    v_max3_f32 v207, v32, v33, v207
    v_max3_f32 v207, v34, v35, v207
    v_max3_f32 v208, v36, v37, v208
    v_max3_f32 v208, v38, v39, v208
    v_max3_f32 v208, v40, v41, v208
    v_max3_f32 v208, v42, v43, v208
    s_add_u32 s64, s64, 32768
    s_cmp_lt_u32 s64, 0x40000
    s_cbranch_scc1 L_slow_loop
    ds_max_f32 v3, v204 offset:0
    ds_max_f32 v3, v205 offset:4
    ds_max_f32 v3, v206 offset:8
    ds_max_f32 v3, v207 offset:12
    ds_max_f32 v3, v208 offset:16
    s_add_u32 m0, s30, 0
    s_nop 0
    buffer_load_dwordx4 v196, s[16:19], s40 offen offset:0 lds
    buffer_load_dwordx4 v197, s[16:19], s40 offen offset:1024 lds
    buffer_load_dwordx4 v198, s[16:19], s40 offen offset:2048 lds
    buffer_load_dwordx4 v199, s[16:19], s40 offen offset:3072 lds
    s_add_u32 m0, s30, 4096
    s_nop 0
    buffer_load_dwordx4 v196, s[16:19], s41 offen offset:0 lds
    buffer_load_dwordx4 v197, s[16:19], s41 offen offset:1024 lds
    buffer_load_dwordx4 v198, s[16:19], s41 offen offset:2048 lds
    buffer_load_dwordx4 v199, s[16:19], s41 offen offset:3072 lds
    s_add_u32 m0, s30, 8192
    s_nop 0
    buffer_load_dwordx4 v196, s[16:19], s42 offen offset:0 lds
    buffer_load_dwordx4 v197, s[16:19], s42 offen offset:1024 lds
    buffer_load_dwordx4 v198, s[16:19], s42 offen offset:2048 lds
    buffer_load_dwordx4 v199, s[16:19], s42 offen offset:3072 lds
    s_add_u32 m0, s30, 12288
    s_nop 0
    buffer_load_dwordx4 v196, s[16:19], s43 offen offset:0 lds
    v_subrev_u32 v52, s30, v184
    v_subrev_u32 v53, s30, v185
    v_subrev_u32 v54, s30, v186
    v_subrev_u32 v55, s30, v187
    s_waitcnt vmcnt(0) lgkmcnt(0)
    s_barrier
    ds_read_b128 v[204:207], v3 offset:0
    ds_read_b32 v208, v3 offset:16
    s_waitcnt lgkmcnt(0)
    s_branch L_main2
L_main2:
    s_nop 0
    ds_read_b128 a[216:219], v52 offset:0
    s_nop 0
    ds_read_b128 a[220:223], v53 offset:0
    s_nop 0
    ds_read_b128 a[224:227], v54 offset:0
    s_nop 0
    ds_read_b128 a[228:231], v55 offset:0
    s_nop 0
    s_nop 0
    s_nop 0
    s_nop 0
    s_nop 0
    s_nop 0
    s_nop 0
    s_waitcnt vmcnt(0) lgkmcnt(0)
    v_mfma_f32_16x16x32_bf16 v[84:87], a[216:219], a[120:123], 0
    buffer_load_dwordx4 v197, s[16:19], s43 offen offset:1024 lds
    s_nop 0
    s_waitcnt vmcnt(0) lgkmcnt(0)
    v_mfma_f32_16x16x32_bf16 v[84:87], a[220:223], a[124:127], v[84:87]
    s_nop 0
    s_waitcnt vmcnt(0) lgkmcnt(0)
    v_mfma_f32_16x16x32_bf16 v[84:87], a[224:227], a[128:131], v[84:87]
    s_nop 0
    s_waitcnt vmcnt(0) lgkmcnt(0)
    v_mfma_f32_16x16x32_bf16 v[84:87], a[228:231], a[132:135], v[84:87]
    s_nop 0
    s_waitcnt vmcnt(0) lgkmcnt(0)
    v_mfma_f32_16x16x32_bf16 v[88:91], a[216:219], a[136:139], 0
    buffer_load_dwordx4 v198, s[16:19], s43 offen offset:2048 lds
    s_nop 0
    s_waitcnt vmcnt(0) lgkmcnt(0)
    v_mfma_f32_16x16x32_bf16 v[88:91], a[220:223], a[140:143], v[88:91]
    s_nop 0
    s_waitcnt vmcnt(0) lgkmcnt(0)
    v_mfma_f32_16x16x32_bf16 v[88:91], a[224:227], a[144:147], v[88:91]
    s_nop 0
    v_max3_f32 v204, v84, v85, v204
    s_waitcnt vmcnt(0) lgkmcnt(0)
    v_mfma_f32_16x16x32_bf16 v[88:91], a[228:231], a[148:151], v[88:91]
    s_nop 0
    v_max3_f32 v204, v86, v87, v204
    s_waitcnt vmcnt(0) lgkmcnt(0)
    v_mfma_f32_16x16x32_bf16 v[92:95], a[216:219], a[152:155], 0
    buffer_load_dwordx4 v199, s[16:19], s43 offen offset:3072 lds
    s_nop 0
    s_waitcnt lgkmcnt(0)
    s_branch L_main3
.section .rodata,"a"
.p2align 6
.amdhsa_kernel standalone__gqa_softmax__near_ridge_kernel
  .amdhsa_next_free_vgpr 512
  .amdhsa_next_free_sgpr 72
  .amdhsa_accum_offset 256
  .amdhsa_group_segment_fixed_size 0
  .amdhsa_kernarg_size 48
  .amdhsa_user_sgpr_count 2
  .amdhsa_user_sgpr_kernarg_segment_ptr 1
  .amdhsa_system_sgpr_workgroup_id_x 1
  .amdhsa_float_denorm_mode_32 3
.end_amdhsa_kernel
```
